```python
import torch

def _softmax(x, axis=-1):
    return torch.softmax(x, dim=axis)
def _gelu(x):
    return torch.nn.functional.gelu(x, approximate="tanh")
def _silu(x):
    return torch.nn.functional.silu(x)
def _sigmoid(x):
    return torch.sigmoid(x)
def _layernorm(x, axis=-1, eps=1e-5):
    m = x.mean(dim=axis, keepdim=True)
    v = x.var(dim=axis, keepdim=True, unbiased=False)
    return (x - m) / torch.sqrt(v + eps)
def _scatter_add(tgt, idx, src, axis=0):
    return tgt.clone().index_add_(axis, idx, src)
def _segment_sum(src, seg, n):
    out = torch.zeros((n,) + src.shape[1:], dtype=src.dtype)
    return out.index_add_(0, seg, src)
def _pad(x, pw):
    flat = tuple(v for pair in reversed(pw) for v in pair)
    return torch.nn.functional.pad(x, flat)

kernel_name = 'parallel_sum__mha_block__mixer_token_mlp__prompt'

def setup_inputs():

    _w = (lambda a: (lambda t: t.to(torch.bfloat16) if t.is_floating_point() else t)(torch.as_tensor(a)))
    def _A_setup():
        B, S, D, H = 1, 2048, 640, 32
        return {
            "x": _w((lambda *s: torch.randn(*s, dtype=torch.bfloat16) * 0.05)(B, S, D)),
            "wqkv": _w((lambda *s: torch.randn(*s, dtype=torch.bfloat16) * 0.05)(D, 3 * D)),
            "wo": _w((lambda *s: torch.randn(*s, dtype=torch.bfloat16) * 0.05)(D, D)),
        }
    _A_in = _A_setup()

    def _B_setup():
        B, S, D, F = 1, 2048, 640, 1536
        return {
            "x": _w((lambda *s: torch.randn(*s, dtype=torch.bfloat16) * 0.05)(B, S, D)),
            "w1": _w((lambda *s: torch.randn(*s, dtype=torch.bfloat16) * 1.6)(S, F) * (S ** -0.5)),
            "b1": _w((lambda *s: torch.randn(*s, dtype=torch.bfloat16) * 12.8)(F) * 0.02),
            "w2": _w((lambda *s: torch.randn(*s, dtype=torch.bfloat16) * 0.8)(F, S) * (F ** -0.5)),
            "b2": _w((lambda *s: torch.randn(*s, dtype=torch.bfloat16) * 12.8)(S) * 0.02),
        }
    _B_in = _B_setup()

    return {
        "A_x": _A_in["x"],
        "A_wqkv": _A_in["wqkv"],
        "A_wo": _A_in["wo"],
        "B_x": _B_in["x"],
        "B_w1": _B_in["w1"],
        "B_b1": _B_in["b1"],
        "B_w2": _B_in["w2"],
        "B_b2": _B_in["b2"],
    }

def reference(A_x, A_wqkv, A_wo, B_x, B_w1, B_b1, B_w2, B_b2):
    def _A_ref(x, wqkv, wo):
        B, S, D = x.shape
        H = 32
        Dh = D // H
        qkv = (lambda x, *d: x.permute(*d))((x @ wqkv).reshape(B, S, 3, H, Dh), 2, 0, 3, 1, 4)
        q, k, v = qkv[0], qkv[1], qkv[2]
        scores = torch.einsum("bhqd,bhkd->bhqk", q, k) * (Dh ** -0.5)
        p = _softmax(scores, axis=-1)
        o = torch.einsum("bhqk,bhkd->bhqd", p, v)
        return (lambda x, *d: x.permute(*d))(o, 0, 2, 1, 3).reshape(B, S, D) @ wo

    def _B_ref(x, w1, b1, w2, b2):
        B, S, D = x.shape
        h = _layernorm(x, axis=-1)
        u = torch.einsum("bsd,sf->bdf", h, w1) + b1
        u = _gelu(u)
        y = torch.einsum("bdf,fs->bds", u, w2) + b2
        return (lambda x, *d: x.permute(*d))(y, 0, 2, 1)

    x = A_x
    xn = _layernorm(x, axis=-1)
    return x + _A_ref(xn, A_wqkv, A_wo) + _B_ref(xn, B_w1, B_b1, B_w2, B_b2)
```

```asm
; @launch grid=(256,1,1) block=(768,1,1) lds=163840
.amdgcn_target "amdgcn-amd-amdhsa--gfx950"
.text
.globl parallel_sum__mha_block__mixer_token_mlp__prompt_kernel
.p2align 8
.type parallel_sum__mha_block__mixer_token_mlp__prompt_kernel,@function
parallel_sum__mha_block__mixer_token_mlp__prompt_kernel:
    s_cmp_ge_u32 s2, 256
    s_cbranch_scc1 k_end
    s_load_dwordx4 s[4:7], s[0:1], 0
    s_load_dwordx2 s[20:21], s[0:1], 80
    s_load_dwordx8 s[56:63], s[0:1], 32
    s_load_dwordx2 s[64:65], s[0:1], 16
    s_load_dwordx2 s[70:71], s[0:1], 64
    s_load_dwordx2 s[72:73], s[0:1], 72
    v_lshrrev_b32 v1, 6, v0
    v_and_b32 v0, 63, v0
    v_readfirstlane_b32 s22, v1
    s_and_b32 s23, s2, 7
    s_lshr_b32 s24, s2, 3
    s_mov_b32 s68, 0x40000
    s_lshr_b32 s74, s23, 1
    s_lshl_b32 s74, s74, 2
    s_lshr_b32 s27, s24, 3
    s_add_u32 s74, s74, s27
    s_and_b32 s25, s2, 1
    s_lshr_b32 s26, s27, 1
    s_lshl_b32 s75, s25, 3
    s_and_b32 s28, s25, s26
    s_sub_u32 s75, s75, s28
    s_and_b32 s27, s24, 7
    s_add_u32 s75, s75, s27
    s_andn2_b32 s26, s26, s25
    s_lshl_b32 s26, s26, 3
    s_add_u32 s26, s26, s27
    s_cmp_eq_u32 s26, 15
    s_cselect_b32 s75, 15, s75
    s_lshl_b32 s76, s23, 5
    s_add_u32 s76, s76, s24
    v_lshlrev_b32 v5, 2, v0
    v_add_u32 v5, 151552, v5
    v_mov_b32 v6, 0
    ds_write_b32 v5, v6
    s_cmp_lt_u32 s22, 4
    s_cbranch_scc1 p1_mma
    s_cmp_ge_u32 s22, 8
    s_cbranch_scc1 p1_ln
p1_stage:
    s_sub_u32 s36, s22, 4
    s_lshl_b32 s39, s36, 12
    v_lshrrev_b32 v2, 3, v0
    v_and_b32 v3, 7, v0
    v_lshrrev_b32 v4, 4, v0
    v_xor_b32 v3, v3, v4
    v_lshlrev_b32 v3, 4, v3
    v_mul_u32_u24 v2, 1280, v2
    v_add_u32 v10, v2, v3
    v_xor_b32 v3, 64, v3
    v_add_u32 v11, v2, v3
    v_add_u32 v12, 18432, v10
    v_add_u32 v13, 27648, v11
    v_add_u32 v11, 9216, v11
    s_mul_i32 s37, s74, 163840
    s_mul_i32 s25, s36, 40960
    s_add_u32 s45, s37, s25
    s_and_b32 s44, s74, 3
    s_mul_i32 s44, s44, 5
    s_and_b32 s25, s24, 7
    s_mul_i32 s25, s25, 5
    s_add_u32 s44, s44, s25
    s_mul_i32 s25, s44, 205
    s_lshr_b32 s25, s25, 11
    s_mul_i32 s25, s25, 10
    s_sub_u32 s44, s44, s25
    s_lshl_b32 s25, s44, 7
    s_add_u32 s37, s45, s25
    v_bfe_u32 v2, v0, 2, 2
    v_mul_u32_u24 v2, 3840, v2
    v_and_b32 v3, 3, v0
    v_lshlrev_b32 v3, 4, v3
    v_lshl_add_u32 v3, v4, 6, v3
    v_add_u32 v14, v2, v3
    v_add_u32 v15, 14336, v14
    v_add_u32 v16, 28672, v14
    v_add_u32 v17, 43008, v14
    s_lshl_b32 s38, s75, 8
    s_mul_i32 s25, s36, 61440
    s_add_u32 s46, s38, s25
    s_mul_i32 s25, s44, 245760
    s_add_u32 s38, s46, s25
    s_mov_b32 m0, s39
    v_mov_b32 v20, 151552
    v_mov_b32 v21, 1
    s_waitcnt lgkmcnt(0)
    s_mov_b32 s12, s4
    s_and_b32 s13, s5, 0xffff
    s_mov_b32 s14, 0x280000
    s_mov_b32 s15, 0x00020000
    s_mov_b32 s16, s6
    s_and_b32 s17, s7, 0xffff
    s_mov_b32 s18, 0x258000
    s_mov_b32 s19, 0x00020000
    s_cmp_eq_u32 s75, 15
    s_cbranch_scc1 p1_stage_spare
    buffer_load_dwordx4 v10, s[12:15], s37 offen offset:0 lds
    buffer_load_dwordx4 v11, s[12:15], s37 offen offset:1024 lds
    buffer_load_dwordx4 v12, s[12:15], s37 offen offset:2048 lds
    buffer_load_dwordx4 v13, s[12:15], s37 offen offset:3072 lds
    s_add_u32 m0, m0, 0x4000
    s_add_u32 s44, s44, 1
    s_cmp_lg_u32 s44, 10
    s_cselect_b32 s44, s44, 0
    s_lshl_b32 s26, s44, 7
    s_add_u32 s37, s45, s26
    buffer_load_dwordx4 v14, s[16:19], s38 offen offset:0 lds
    buffer_load_dwordx4 v15, s[16:19], s38 offen offset:1024 lds
    buffer_load_dwordx4 v16, s[16:19], s38 offen offset:2048 lds
    buffer_load_dwordx4 v17, s[16:19], s38 offen offset:3072 lds
    s_add_u32 m0, m0, 0x4000
    s_mul_i32 s26, s44, 245760
    s_add_u32 s38, s46, s26
    buffer_load_dwordx4 v10, s[12:15], s37 offen offset:0 lds
    buffer_load_dwordx4 v11, s[12:15], s37 offen offset:1024 lds
    buffer_load_dwordx4 v12, s[12:15], s37 offen offset:2048 lds
    buffer_load_dwordx4 v13, s[12:15], s37 offen offset:3072 lds
    s_add_u32 m0, m0, 0x4000
    s_add_u32 s44, s44, 1
    s_cmp_lg_u32 s44, 10
    s_cselect_b32 s44, s44, 0
    s_lshl_b32 s26, s44, 7
    s_add_u32 s37, s45, s26
    buffer_load_dwordx4 v14, s[16:19], s38 offen offset:0 lds
    buffer_load_dwordx4 v15, s[16:19], s38 offen offset:1024 lds
    buffer_load_dwordx4 v16, s[16:19], s38 offen offset:2048 lds
    buffer_load_dwordx4 v17, s[16:19], s38 offen offset:3072 lds
    s_add_u32 m0, m0, 0x4000
    s_mul_i32 s26, s44, 245760
    s_add_u32 s38, s46, s26
    s_mov_b32 s8, s20
    s_and_b32 s9, s21, 0xffff
    s_mov_b32 s10, 0x1300000
    s_mov_b32 s11, 0x00020000
    s_add_u32 s25, s39, 0x4000
    v_lshl_add_u32 v18, v0, 4, s25
    v_mov_b32 v19, v18
    v_mov_b32 v24, 0
    v_mov_b32 v25, 0
    v_mov_b32 v26, 0
    v_mov_b32 v27, 0
    v_mov_b32 v28, 0
    v_mov_b32 v29, 0
    v_mov_b32 v30, 0
    v_mov_b32 v31, 0
    s_mov_b32 s42, 0xffff0000
    s_mov_b32 s41, 0
    s_mov_b32 s40, 7
p1s_loop:
    s_waitcnt vmcnt(8)
    s_barrier
    ds_read_b128 v[32:35], v19 offset:0
    ds_read_b128 v[36:39], v19 offset:1024
    ds_read_b128 v[40:43], v19 offset:2048
    ds_read_b128 v[44:47], v19 offset:3072
    s_add_u32 s41, s41, 0x8000
    s_and_b32 s41, s41, 0x1ffff
    v_xor_b32 v19, s41, v18
    buffer_load_dwordx4 v10, s[12:15], s37 offen offset:0 lds
    buffer_load_dwordx4 v11, s[12:15], s37 offen offset:1024 lds
    buffer_load_dwordx4 v12, s[12:15], s37 offen offset:2048 lds
    s_waitcnt lgkmcnt(0)
    buffer_load_dwordx4 v13, s[12:15], s37 offen offset:3072 lds
    s_add_u32 m0, m0, 0x4000
    s_add_u32 s44, s44, 1
    s_cmp_lg_u32 s44, 10
    s_cselect_b32 s44, s44, 0
    s_lshl_b32 s26, s44, 7
    s_add_u32 s37, s45, s26
    v_lshlrev_b32 v2, 16, v32
    v_and_b32 v3, s42, v32
    v_lshlrev_b32 v4, 16, v33
    v_and_b32 v5, s42, v33
    v_add_f32 v24, v24, v2
    v_add_f32 v25, v25, v3
    v_lshlrev_b32 v2, 16, v34
    v_and_b32 v3, s42, v34
    v_add_f32 v26, v26, v4
    v_add_f32 v27, v27, v5
    v_lshlrev_b32 v4, 16, v35
    v_and_b32 v5, s42, v35
    buffer_load_dwordx4 v14, s[16:19], s38 offen offset:0 lds
    v_add_f32 v28, v28, v2
    v_add_f32 v29, v29, v3
    v_lshlrev_b32 v2, 16, v36
    v_and_b32 v3, s42, v36
    v_add_f32 v30, v30, v4
    v_add_f32 v31, v31, v5
    v_lshlrev_b32 v4, 16, v37
    v_and_b32 v5, s42, v37
    v_add_f32 v24, v24, v2
    v_add_f32 v25, v25, v3
    v_lshlrev_b32 v2, 16, v38
    v_and_b32 v3, s42, v38
    v_add_f32 v26, v26, v4
    buffer_load_dwordx4 v15, s[16:19], s38 offen offset:1024 lds
    v_add_f32 v27, v27, v5
    v_lshlrev_b32 v4, 16, v39
    v_and_b32 v5, s42, v39
    v_add_f32 v28, v28, v2
    v_add_f32 v29, v29, v3
    v_add_f32 v30, v30, v4
    v_add_f32 v31, v31, v5
    v_lshlrev_b32 v2, 16, v40
    v_and_b32 v3, s42, v40
    v_lshlrev_b32 v4, 16, v41
    v_and_b32 v5, s42, v41
    v_add_f32 v24, v24, v2
    v_add_f32 v25, v25, v3
    buffer_load_dwordx4 v16, s[16:19], s38 offen offset:2048 lds
    v_lshlrev_b32 v2, 16, v42
    v_and_b32 v3, s42, v42
    v_add_f32 v26, v26, v4
    v_add_f32 v27, v27, v5
    v_lshlrev_b32 v4, 16, v43
    v_and_b32 v5, s42, v43
    v_add_f32 v28, v28, v2
    v_add_f32 v29, v29, v3
    v_lshlrev_b32 v2, 16, v44
    v_and_b32 v3, s42, v44
    v_add_f32 v30, v30, v4
    v_add_f32 v31, v31, v5
    v_lshlrev_b32 v4, 16, v45
    buffer_load_dwordx4 v17, s[16:19], s38 offen offset:3072 lds
    s_add_u32 m0, m0, 0x4000
    s_mul_i32 s26, s44, 245760
    s_add_u32 s38, s46, s26
    v_and_b32 v5, s42, v45
    v_add_f32 v24, v24, v2
    v_add_f32 v25, v25, v3
    v_lshlrev_b32 v2, 16, v46
    v_and_b32 v3, s42, v46
    v_add_f32 v26, v26, v4
    v_add_f32 v27, v27, v5
    v_lshlrev_b32 v4, 16, v47
    v_and_b32 v5, s42, v47
    v_add_f32 v28, v28, v2
    v_add_f32 v29, v29, v3
    v_add_f32 v30, v30, v4
    v_add_f32 v31, v31, v5
    s_and_b32 m0, m0, 0x1ffff
    s_sub_u32 s40, s40, 1
    s_cbranch_scc0 p1s_loop
    s_setprio 2
    s_waitcnt vmcnt(8)
    s_barrier
    ds_read_b128 v[32:35], v19 offset:0
    ds_read_b128 v[36:39], v19 offset:1024
    ds_read_b128 v[40:43], v19 offset:2048
    ds_read_b128 v[44:47], v19 offset:3072
    s_add_u32 s41, s41, 0x8000
    s_and_b32 s41, s41, 0x1ffff
    v_xor_b32 v19, s41, v18
    s_waitcnt lgkmcnt(0)
    v_lshlrev_b32 v2, 16, v32
    v_and_b32 v3, s42, v32
    v_lshlrev_b32 v4, 16, v33
    v_and_b32 v5, s42, v33
    v_add_f32 v24, v24, v2
    v_add_f32 v25, v25, v3
    v_lshlrev_b32 v2, 16, v34
    v_and_b32 v3, s42, v34
    v_add_f32 v26, v26, v4
    v_add_f32 v27, v27, v5
    v_lshlrev_b32 v4, 16, v35
    v_and_b32 v5, s42, v35
    v_add_f32 v28, v28, v2
    v_add_f32 v29, v29, v3
    v_lshlrev_b32 v2, 16, v36
    v_and_b32 v3, s42, v36
    v_add_f32 v30, v30, v4
    v_add_f32 v31, v31, v5
    v_lshlrev_b32 v4, 16, v37
    v_and_b32 v5, s42, v37
    v_add_f32 v24, v24, v2
    v_add_f32 v25, v25, v3
    v_lshlrev_b32 v2, 16, v38
    v_and_b32 v3, s42, v38
    v_add_f32 v26, v26, v4
    v_add_f32 v27, v27, v5
    v_lshlrev_b32 v4, 16, v39
    v_and_b32 v5, s42, v39
    v_add_f32 v28, v28, v2
    v_add_f32 v29, v29, v3
    v_add_f32 v30, v30, v4
    v_add_f32 v31, v31, v5
    v_lshlrev_b32 v2, 16, v40
    v_and_b32 v3, s42, v40
    v_lshlrev_b32 v4, 16, v41
    v_and_b32 v5, s42, v41
    v_add_f32 v24, v24, v2
    v_add_f32 v25, v25, v3
    v_lshlrev_b32 v2, 16, v42
    v_and_b32 v3, s42, v42
    v_add_f32 v26, v26, v4
    v_add_f32 v27, v27, v5
    v_lshlrev_b32 v4, 16, v43
    v_and_b32 v5, s42, v43
    v_add_f32 v28, v28, v2
    v_add_f32 v29, v29, v3
    v_lshlrev_b32 v2, 16, v44
    v_and_b32 v3, s42, v44
    v_add_f32 v30, v30, v4
    v_add_f32 v31, v31, v5
    v_lshlrev_b32 v4, 16, v45
    v_and_b32 v5, s42, v45
    v_add_f32 v24, v24, v2
    v_add_f32 v25, v25, v3
    v_lshlrev_b32 v2, 16, v46
    v_and_b32 v3, s42, v46
    v_add_f32 v26, v26, v4
    v_add_f32 v27, v27, v5
    v_lshlrev_b32 v4, 16, v47
    v_and_b32 v5, s42, v47
    v_add_f32 v28, v28, v2
    v_add_f32 v29, v29, v3
    v_add_f32 v30, v30, v4
    v_add_f32 v31, v31, v5
    s_waitcnt vmcnt(0)
    s_barrier
    ds_read_b128 v[32:35], v19 offset:0
    ds_read_b128 v[36:39], v19 offset:1024
    ds_read_b128 v[40:43], v19 offset:2048
    ds_read_b128 v[44:47], v19 offset:3072
    s_add_u32 s41, s41, 0x8000
    s_and_b32 s41, s41, 0x1ffff
    v_xor_b32 v19, s41, v18
    s_waitcnt lgkmcnt(0)
    v_lshlrev_b32 v2, 16, v32
    v_and_b32 v3, s42, v32
    v_lshlrev_b32 v4, 16, v33
    v_and_b32 v5, s42, v33
    v_add_f32 v24, v24, v2
    v_add_f32 v25, v25, v3
    v_lshlrev_b32 v2, 16, v34
    v_and_b32 v3, s42, v34
    v_add_f32 v26, v26, v4
    v_add_f32 v27, v27, v5
    v_lshlrev_b32 v4, 16, v35
    v_and_b32 v5, s42, v35
    v_add_f32 v28, v28, v2
    v_add_f32 v29, v29, v3
    v_lshlrev_b32 v2, 16, v36
    v_and_b32 v3, s42, v36
    v_add_f32 v30, v30, v4
    v_add_f32 v31, v31, v5
    v_lshlrev_b32 v4, 16, v37
    v_and_b32 v5, s42, v37
    v_add_f32 v24, v24, v2
    v_add_f32 v25, v25, v3
    v_lshlrev_b32 v2, 16, v38
    v_and_b32 v3, s42, v38
    v_add_f32 v26, v26, v4
    v_add_f32 v27, v27, v5
    v_lshlrev_b32 v4, 16, v39
    v_and_b32 v5, s42, v39
    v_add_f32 v28, v28, v2
    v_add_f32 v29, v29, v3
    v_add_f32 v30, v30, v4
    v_add_f32 v31, v31, v5
    v_lshlrev_b32 v2, 16, v40
    v_and_b32 v3, s42, v40
    v_lshlrev_b32 v4, 16, v41
    v_and_b32 v5, s42, v41
    v_add_f32 v24, v24, v2
    v_add_f32 v25, v25, v3
    v_lshlrev_b32 v2, 16, v42
    v_and_b32 v3, s42, v42
    v_add_f32 v26, v26, v4
    v_add_f32 v27, v27, v5
    v_lshlrev_b32 v4, 16, v43
    v_and_b32 v5, s42, v43
    v_add_f32 v28, v28, v2
    v_add_f32 v29, v29, v3
    v_lshlrev_b32 v2, 16, v44
    v_and_b32 v3, s42, v44
    v_add_f32 v30, v30, v4
    v_add_f32 v31, v31, v5
    v_lshlrev_b32 v4, 16, v45
    v_and_b32 v5, s42, v45
    v_add_f32 v24, v24, v2
    v_add_f32 v25, v25, v3
    v_lshlrev_b32 v2, 16, v46
    v_and_b32 v3, s42, v46
    v_add_f32 v26, v26, v4
    v_add_f32 v27, v27, v5
    v_lshlrev_b32 v4, 16, v47
    v_and_b32 v5, s42, v47
    v_add_f32 v28, v28, v2
    v_add_f32 v29, v29, v3
    v_add_f32 v30, v30, v4
    v_add_f32 v31, v31, v5
    s_nop 0
    v_add_f32_dpp v24, v24, v24 row_ror:4 row_mask:0xf bank_mask:0xf
    v_add_f32_dpp v25, v25, v25 row_ror:4 row_mask:0xf bank_mask:0xf
    v_add_f32_dpp v26, v26, v26 row_ror:4 row_mask:0xf bank_mask:0xf
    v_add_f32_dpp v27, v27, v27 row_ror:4 row_mask:0xf bank_mask:0xf
    v_add_f32_dpp v28, v28, v28 row_ror:4 row_mask:0xf bank_mask:0xf
    v_add_f32_dpp v29, v29, v29 row_ror:4 row_mask:0xf bank_mask:0xf
    v_add_f32_dpp v30, v30, v30 row_ror:4 row_mask:0xf bank_mask:0xf
    v_add_f32_dpp v31, v31, v31 row_ror:4 row_mask:0xf bank_mask:0xf
    v_add_f32_dpp v24, v24, v24 row_ror:8 row_mask:0xf bank_mask:0xf
    v_add_f32_dpp v25, v25, v25 row_ror:8 row_mask:0xf bank_mask:0xf
    v_add_f32_dpp v26, v26, v26 row_ror:8 row_mask:0xf bank_mask:0xf
    v_add_f32_dpp v27, v27, v27 row_ror:8 row_mask:0xf bank_mask:0xf
    v_add_f32_dpp v28, v28, v28 row_ror:8 row_mask:0xf bank_mask:0xf
    v_add_f32_dpp v29, v29, v29 row_ror:8 row_mask:0xf bank_mask:0xf
    v_add_f32_dpp v30, v30, v30 row_ror:8 row_mask:0xf bank_mask:0xf
    v_add_f32_dpp v31, v31, v31 row_ror:8 row_mask:0xf bank_mask:0xf
    v_lshrrev_b32 v2, 4, v0
    v_and_b32 v3, 3, v0
    v_lshlrev_b32 v2, 7, v2
    v_lshl_add_u32 v2, v3, 5, v2
    s_lshl_b32 s25, s36, 9
    s_add_u32 s25, s25, 153600
    v_add_u32 v2, s25, v2
    ds_write_b128 v2, v[24:27]
    ds_write_b128 v2, v[28:31] offset:16
    s_waitcnt lgkmcnt(0)
    v_mov_b32 v6, 1
    s_mov_b64 exec, 1
    ds_add_u32 v20, v6 offset:36
    s_mov_b64 exec, -1
    v_mov_b32 v6, 1
    s_mov_b64 exec, 1
    ds_add_u32 v20, v6 offset:32
    s_mov_b64 exec, -1
p1s_bcs_spin:
    ds_read_b32 v6, v20 offset:36
    s_waitcnt lgkmcnt(0)
    v_readfirstlane_b32 s25, v6
    s_cmp_ge_u32 s25, 4
    s_cbranch_scc1 p1s_bcs_done
    s_sleep 1
    s_sub_u32 s68, s68, 1
    s_cbranch_scc0 p1s_bcs_spin
    s_mov_b32 s68, 0
p1s_bcs_done:
    v_and_b32 v2, 31, v0
    s_lshl_b32 s25, s36, 7
    s_add_u32 s25, s25, 153088
    v_lshl_add_u32 v2, v2, 2, s25
    ds_read_b32 v24, v2 offset:512
    ds_read_b32 v25, v2 offset:1024
    ds_read_b32 v26, v2 offset:1536
    ds_read_b32 v27, v2 offset:2048
    s_waitcnt lgkmcnt(0)
    v_add_f32 v24, v24, v25
    v_add_f32 v26, v26, v27
    v_add_f32 v24, v24, v26
    ds_write_b32 v2, v24
    s_waitcnt lgkmcnt(0)
    v_mov_b32 v6, 1
    s_mov_b64 exec, 1
    ds_add_u32 v20, v6 offset:28
    s_mov_b64 exec, -1
    s_setprio 0
    s_branch p2_attn
p1_stage_spare:
    s_mov_b32 s8, s20
    s_and_b32 s9, s21, 0xffff
    s_mov_b32 s10, 0x1300000
    s_mov_b32 s11, 0x00020000
    s_branch p1_spare_work
p1_ln:
    s_setprio 1
    s_sub_u32 s36, s22, 8
    s_lshl_b32 s39, s36, 14
    s_mov_b32 s29, 0
    s_lshr_b32 s25, s76, 1
    s_lshl_b32 s25, s25, 4
    s_and_b32 s26, s76, 1
    s_lshl_b32 s26, s26, 2
    s_add_u32 s25, s25, s26
    s_and_b32 s26, s36, 1
    s_lshl_b32 s26, s26, 1
    s_add_u32 s25, s25, s26
    s_lshr_b32 s26, s36, 1
    s_lshl_b32 s26, s26, 3
    s_add_u32 s42, s25, s26
    s_mul_i32 s28, s42, 1280
    v_lshrrev_b32 v1, 5, v0
    v_and_b32 v2, 31, v0
    v_mul_u32_u24 v3, 1280, v1
    v_lshl_add_u32 v3, v2, 3, v3
    s_waitcnt lgkmcnt(0)
    s_mov_b32 s12, s4
    s_and_b32 s13, s5, 0xffff
    s_mov_b32 s14, 0x280000
    s_mov_b32 s15, 0x00020000
    buffer_load_dwordx2 v[8:9], v3, s[12:15], s28 offen offset:0
    buffer_load_dwordx2 v[10:11], v3, s[12:15], s28 offen offset:256
    buffer_load_dwordx2 v[12:13], v3, s[12:15], s28 offen offset:512
    buffer_load_dwordx2 v[14:15], v3, s[12:15], s28 offen offset:768
    buffer_load_dwordx2 v[16:17], v3, s[12:15], s28 offen offset:1024
    s_mov_b32 s8, s20
    s_and_b32 s9, s21, 0xffff
    s_mov_b32 s10, 0x1300000
    s_mov_b32 s11, 0x00020000
    s_mul_i32 s25, s24, 43
    s_lshr_b32 s41, s25, 7
    s_mul_i32 s25, s41, 3
    s_sub_u32 s25, s24, s25
    s_mul_i32 s40, s23, 3
    s_add_u32 s40, s40, s25
    s_lshr_b32 s27, s36, 1
    s_lshl_b32 s27, s27, 6
    s_lshl_b32 s26, s40, 7
    s_add_u32 s66, s27, s26
    s_load_dword s27, s[58:59], s66
    s_lshr_b32 s25, s23, 1
    s_lshl_b32 s25, s25, 3
    s_and_b32 s26, s24, 7
    s_add_u32 s25, s25, s26
    s_lshl_b32 s25, s25, 2
    s_add_u32 s25, s25, s36
    s_lshl_b32 s69, s25, 5
    s_load_dword s26, s[62:63], s69
    s_barrier
    s_mov_b32 s43, 0xffff0000
    s_waitcnt vmcnt(0) lgkmcnt(0)
    v_lshlrev_b32 v24, 16, v8
    v_and_b32 v25, s43, v8
    v_lshlrev_b32 v26, 16, v9
    v_and_b32 v27, s43, v9
    v_lshlrev_b32 v28, 16, v10
    v_and_b32 v29, s43, v10
    v_lshlrev_b32 v30, 16, v11
    v_and_b32 v31, s43, v11
    v_lshlrev_b32 v32, 16, v12
    v_and_b32 v33, s43, v12
    v_lshlrev_b32 v34, 16, v13
    v_and_b32 v35, s43, v13
    v_lshlrev_b32 v36, 16, v14
    v_and_b32 v37, s43, v14
    v_lshlrev_b32 v38, 16, v15
    v_and_b32 v39, s43, v15
    v_lshlrev_b32 v40, 16, v16
    v_and_b32 v41, s43, v16
    v_lshlrev_b32 v42, 16, v17
    v_and_b32 v43, s43, v17
    v_add_f32 v4, v24, v25
    v_mul_f32 v5, v24, v24
    v_add_f32 v6, v26, v27
    v_mul_f32 v7, v25, v25
    v_fmac_f32 v5, v26, v26
    v_fmac_f32 v7, v27, v27
    v_add_f32 v4, v4, v28
    v_fmac_f32 v5, v28, v28
    v_add_f32 v6, v6, v29
    v_fmac_f32 v7, v29, v29
    v_add_f32 v4, v4, v30
    v_fmac_f32 v5, v30, v30
    v_add_f32 v6, v6, v31
    v_fmac_f32 v7, v31, v31
    v_add_f32 v4, v4, v32
    v_fmac_f32 v5, v32, v32
    v_add_f32 v6, v6, v33
    v_fmac_f32 v7, v33, v33
    v_add_f32 v4, v4, v34
    v_fmac_f32 v5, v34, v34
    v_add_f32 v6, v6, v35
    v_fmac_f32 v7, v35, v35
    v_add_f32 v4, v4, v36
    v_fmac_f32 v5, v36, v36
    v_add_f32 v6, v6, v37
    v_fmac_f32 v7, v37, v37
    v_add_f32 v4, v4, v38
    v_fmac_f32 v5, v38, v38
    v_add_f32 v6, v6, v39
    v_fmac_f32 v7, v39, v39
    v_add_f32 v4, v4, v40
    v_fmac_f32 v5, v40, v40
    v_add_f32 v6, v6, v41
    v_fmac_f32 v7, v41, v41
    v_add_f32 v4, v4, v42
    v_fmac_f32 v5, v42, v42
    v_add_f32 v6, v6, v43
    v_fmac_f32 v7, v43, v43
    v_add_f32 v4, v4, v6
    v_add_f32 v5, v5, v7
    s_nop 0
    v_add_f32_dpp v4, v4, v4 quad_perm:[1,0,3,2] row_mask:0xf bank_mask:0xf
    v_add_f32_dpp v5, v5, v5 quad_perm:[1,0,3,2] row_mask:0xf bank_mask:0xf
    s_nop 0
    v_add_f32_dpp v4, v4, v4 quad_perm:[2,3,0,1] row_mask:0xf bank_mask:0xf
    v_add_f32_dpp v5, v5, v5 quad_perm:[2,3,0,1] row_mask:0xf bank_mask:0xf
    s_nop 0
    v_add_f32_dpp v4, v4, v4 row_half_mirror row_mask:0xf bank_mask:0xf
    v_add_f32_dpp v5, v5, v5 row_half_mirror row_mask:0xf bank_mask:0xf
    s_nop 0
    v_add_f32_dpp v4, v4, v4 row_mirror row_mask:0xf bank_mask:0xf
    v_add_f32_dpp v5, v5, v5 row_mirror row_mask:0xf bank_mask:0xf
    s_nop 0
    v_mov_b32 v6, v4
    v_mov_b32 v7, v5
    s_nop 1
    v_permlane16_swap_b32 v4, v6
    v_permlane16_swap_b32 v5, v7
    s_nop 1
    v_add_f32 v4, v4, v6
    v_add_f32 v5, v5, v7
    v_mul_f32 v4, 0xbacccccd, v4
    v_mul_f32 v5, 0x3acccccd, v5
    v_fma_f32 v6, -v4, v4, v5
    v_max_f32 v6, 0, v6
    v_add_f32 v5, 0x3727c5ac, v6
    v_rsq_f32 v5, v5
    v_mov_b32 v20, 0x3727c5ac
    v_mul_f32 v7, v5, v5
    v_fma_f32 v7, v7, v6, v20
    v_rsq_f32 v7, v7
    s_lshl_b32 s25, s42, 3
    v_mul_f32 v7, v7, v5
    v_mul_f32 v6, v4, v7
    s_add_u32 s25, s25, 0x1230000
    v_lshlrev_b32 v20, 3, v1
    s_mov_b32 exec_lo, 1
    s_mov_b32 exec_hi, 1
    buffer_store_dwordx2 v[4:5], v20, s[8:11], s25 offen sc1
    s_mov_b64 exec, -1
    v_fma_f32 v24, v24, v7, v6
    v_fma_f32 v25, v25, v7, v6
    v_fma_f32 v26, v26, v7, v6
    v_fma_f32 v27, v27, v7, v6
    v_fma_f32 v28, v28, v7, v6
    v_fma_f32 v29, v29, v7, v6
    v_fma_f32 v30, v30, v7, v6
    v_fma_f32 v31, v31, v7, v6
    v_fma_f32 v32, v32, v7, v6
    v_fma_f32 v33, v33, v7, v6
    v_fma_f32 v34, v34, v7, v6
    v_fma_f32 v35, v35, v7, v6
    v_fma_f32 v36, v36, v7, v6
    v_fma_f32 v37, v37, v7, v6
    v_fma_f32 v38, v38, v7, v6
    v_fma_f32 v39, v39, v7, v6
    v_fma_f32 v40, v40, v7, v6
    v_fma_f32 v41, v41, v7, v6
    v_fma_f32 v42, v42, v7, v6
    v_fma_f32 v43, v43, v7, v6
    v_cvt_pk_bf16_f32 v8, v24, v25
    v_cvt_pk_bf16_f32 v9, v26, v27
    v_cvt_pk_bf16_f32 v10, v28, v29
    v_cvt_pk_bf16_f32 v11, v30, v31
    v_cvt_pk_bf16_f32 v12, v32, v33
    v_cvt_pk_bf16_f32 v13, v34, v35
    v_cvt_pk_bf16_f32 v14, v36, v37
    v_cvt_pk_bf16_f32 v15, v38, v39
    v_cvt_pk_bf16_f32 v16, v40, v41
    v_cvt_pk_bf16_f32 v17, v42, v43
    s_mul_i32 s25, s36, 2592
    s_add_u32 s25, s25, 131072
    v_mul_u32_u24 v3, 1296, v1
    v_lshl_add_u32 v3, v2, 3, v3
    v_add_u32 v3, s25, v3
    ds_write_b64 v3, v[8:9] offset:0
    ds_write_b64 v3, v[10:11] offset:256
    ds_write_b64 v3, v[12:13] offset:512
    ds_write_b64 v3, v[14:15] offset:768
    ds_write_b64 v3, v[16:17] offset:1024
    s_waitcnt lgkmcnt(0)
    s_barrier
    v_bfe_u32 v3, v0, 2, 2
    v_mul_u32_u24 v3, 1296, v3
    v_and_b32 v4, 3, v0
    v_lshl_add_u32 v3, v4, 3, v3
    v_lshrrev_b32 v4, 4, v0
    v_lshl_add_u32 v3, v4, 5, v3
    s_lshl_b32 s25, s36, 7
    s_add_u32 s25, s25, 131072
    v_add_u32 v3, s25, v3
    v_lshlrev_b32 v4, 17, v1
    v_lshl_add_u32 v4, v2, 4, v4
    s_lshl_b32 s27, s76, 9
    s_lshl_b32 s28, s36, 18
    s_add_u32 s27, s27, s28
    s_add_u32 s27, s27, 0x780000
    s_mov_b32 s44, s27
    ds_read_b64_tr_b16 v[24:25], v3 offset:0
    ds_read_b64_tr_b16 v[26:27], v3 offset:5184
    ds_read_b64_tr_b16 v[28:29], v3 offset:512
    ds_read_b64_tr_b16 v[30:31], v3 offset:5696
    s_cmp_ge_u32 s36, 2
    s_cbranch_scc1 p1l_h2
    ds_read_b64_tr_b16 v[32:33], v3 offset:1024
    ds_read_b64_tr_b16 v[34:35], v3 offset:6208
p1l_h2:
    s_waitcnt lgkmcnt(0)
    buffer_store_dwordx4 v[24:27], v4, s[8:11], s44 offen sc1
    s_add_u32 s44, s44, 1048576
    buffer_store_dwordx4 v[28:31], v4, s[8:11], s44 offen sc1
    s_add_u32 s44, s44, 1048576
    s_cmp_ge_u32 s36, 2
    s_cbranch_scc1 p1l_h3
    buffer_store_dwordx4 v[32:35], v4, s[8:11], s44 offen sc1
    s_add_u32 s44, s44, 1048576
p1l_h3:
    s_barrier
    s_barrier
    s_barrier
    s_barrier
    s_mov_b32 s16, s72
    s_and_b32 s17, s73, 0xffff
    s_mov_b32 s18, 0x100
    s_mov_b32 s19, 0x00020000
    s_lshr_b32 s28, s76, 4
    s_lshl_b32 s28, s28, 8
    s_add_u32 s28, s28, 0x1200000
    v_mov_b32 v5, 151552
    v_mov_b32 v6, 1
    s_waitcnt vmcnt(0)
    s_mov_b64 exec, 1
    ds_add_rtn_u32 v7, v5, v6 offset:52
    s_waitcnt lgkmcnt(0)
    v_readfirstlane_b32 s25, v7
    s_cmp_lg_u32 s25, 3
    s_cbranch_scc1 p1l_nl
p1l_ini:
    buffer_load_dword v7, off, s[16:19], 0 sc1
    s_waitcnt vmcnt(0)
    v_readfirstlane_b32 s25, v7
    s_cmp_lg_u32 s25, 0
    s_cbranch_scc1 p1l_iok
    s_sleep 2
    s_sub_u32 s68, s68, 1
    s_cbranch_scc0 p1l_ini
    s_mov_b32 s68, 0
p1l_iok:
    buffer_atomic_add v6, off, s[8:11], s28
    ds_add_u32 v5, v6 offset:52
p1l_nl:
    s_mov_b64 exec, -1
    s_barrier
    s_barrier
    s_barrier
    s_barrier
    s_cmp_lg_u32 s36, 0
    s_cbranch_scc1 p1l_wait
    v_mov_b32 v5, 151552
p1l_ic_spin:
    ds_read_b32 v6, v5 offset:52
    s_waitcnt lgkmcnt(0)
    v_readfirstlane_b32 s25, v6
    s_cmp_ge_u32 s25, 5
    s_cbranch_scc1 p1l_ic_done
    s_sleep 2
    s_sub_u32 s68, s68, 1
    s_cbranch_scc0 p1l_ic_spin
    s_mov_b32 s68, 0
p1l_ic_done:
    v_and_b32 v3, 15, v0
    v_lshlrev_b32 v3, 8, v3
    s_mov_b32 s26, 0x1200000
p1l_h_poll:
    buffer_load_dword v6, v3, s[8:11], s26 offen sc1
    s_waitcnt vmcnt(0)
    v_cmp_gt_u32 vcc, 16, v6
    s_nop 4
    s_cbranch_vccz p1l_h_go
    s_sleep 2
    s_sub_u32 s68, s68, 1
    s_cbranch_scc0 p1l_h_poll
    s_mov_b32 s68, 0
p1l_h_go:
    s_lshl_b32 s25, s74, 10
    s_add_u32 s25, s25, 0x1230000
    v_lshlrev_b32 v3, 4, v0
    buffer_load_dwordx4 v[8:11], v3, s[8:11], s25 offen sc1
    s_cmp_lt_u32 s75, 5
    s_cselect_b32 s26, 0x3ea52b5c, 1.0
    v_lshlrev_b32 v3, 3, v0
    v_add_u32 v3, 152064, v3
    s_waitcnt vmcnt(0)
    v_mov_b32 v12, v8
    v_mov_b32 v13, v10
    v_mul_f32 v14, s26, v9
    v_mul_f32 v15, s26, v11
    ds_write_b64 v3, v[12:13]
    ds_write_b64 v3, v[14:15] offset:512
    s_waitcnt lgkmcnt(0)
    v_mov_b32 v5, 151552
    v_mov_b32 v6, 1
    s_mov_b64 exec, 1
    ds_add_u32 v5, v6 offset:28
    s_mov_b64 exec, -1
    v_mov_b32 v5, 151552
    v_mov_b32 v6, 1
    s_mov_b64 exec, 1
    ds_add_u32 v5, v6 offset:60
    s_mov_b64 exec, -1
p1l_wait:
    s_setprio 1
    s_mov_b32 s16, s58
    s_and_b32 s17, s59, 0xffff
    s_mov_b32 s18, 0xc00
    s_mov_b32 s19, 0x00020000
    v_lshrrev_b32 v7, 5, v0
    v_lshlrev_b32 v7, 3, v7
    buffer_load_dwordx2 v[154:155], v7, s[16:19], s66 offen offset:0
    buffer_load_dwordx2 v[156:157], v7, s[16:19], s66 offen offset:16
    buffer_load_dwordx2 v[158:159], v7, s[16:19], s66 offen offset:32
    buffer_load_dwordx2 v[160:161], v7, s[16:19], s66 offen offset:48
    s_mov_b32 s16, s62
    s_and_b32 s17, s63, 0xffff
    s_mov_b32 s18, 0x1000
    s_mov_b32 s19, 0x00020000
    v_and_b32 v7, 15, v0
    v_lshlrev_b32 v7, 1, v7
    buffer_load_ushort v163, v7, s[16:19], s69 offen
    s_cmp_lt_u32 s24, 30
    s_cbranch_scc1 m1_go
    s_mov_b32 s67, 0
    v_mov_b32 v5, 151552
m0_hok_spin:
    ds_read_b32 v6, v5 offset:60
    s_waitcnt lgkmcnt(0)
    v_readfirstlane_b32 s25, v6
    s_cmp_ge_u32 s25, 1
    s_cbranch_scc1 m0_hok_done
    s_sleep 8
    s_sub_u32 s68, s68, 1
    s_cbranch_scc0 m0_hok_spin
    s_mov_b32 s68, 0
m0_hok_done:
    v_mov_b32 v5, 151552
m0_p1_spin:
    ds_read_b32 v6, v5 offset:32
    s_waitcnt lgkmcnt(0)
    v_readfirstlane_b32 s25, v6
    s_cmp_ge_u32 s25, 8
    s_cbranch_scc1 m0_p1_done
    s_sleep 4
    s_sub_u32 s68, s68, 1
    s_cbranch_scc0 m0_p1_spin
    s_mov_b32 s68, 0
m0_p1_done:
    s_cmp_lg_u32 s75, 15
    s_cselect_b32 s27, 4, 0
    v_mov_b32 v5, 151552
m0_q_spin:
    ds_read_b32 v6, v5 offset:40
    s_waitcnt lgkmcnt(0)
    v_readfirstlane_b32 s25, v6
    s_cmp_ge_u32 s25, s27
    s_cbranch_scc1 m0_q_done
    s_sleep 2
    s_sub_u32 s68, s68, 1
    s_cbranch_scc0 m0_q_spin
    s_mov_b32 s68, 0
m0_q_done:
    v_mov_b32 v5, 151552
m0_go_spin:
    ds_read_b32 v6, v5 offset:44
    s_waitcnt lgkmcnt(0)
    v_readfirstlane_b32 s25, v6
    s_cmp_ge_u32 s25, 1
    s_cbranch_scc1 m0_go_done
    s_sleep 8
    s_sub_u32 s68, s68, 1
    s_cbranch_scc0 m0_go_spin
    s_mov_b32 s68, 0
m0_go_done:
    s_and_b32 s42, s24, 1
    s_lshl_b32 s42, s42, 3
    s_add_u32 s42, s42, s23
    s_lshl_b32 s42, s42, 2
    s_add_u32 s42, s42, s36
    s_mov_b32 s44, s42
    s_mov_b32 s12, s56
    s_and_b32 s13, s57, 0xffff
    s_mov_b32 s14, 0x600000
    s_mov_b32 s15, 0x00020000
    v_lshlrev_b32 v5, 7, v0
    v_min_u32 v5, 6080, v5
    s_and_b32 s25, s44, 3
    s_mul_i32 s25, s25, 512
    s_lshr_b32 s26, s44, 2
    s_lshl_b32 s26, s26, 1
    s_add_u32 s25, s25, s26
    s_add_u32 s25, s25, 320
    s_mul_i32 s25, s25, 3072
    buffer_load_dword v164, v5, s[12:15], s25 offen
    s_add_u32 s25, s25, 98304
    s_waitcnt vmcnt(1)
    buffer_load_dword v165, v5, s[12:15], s25 offen
    s_add_u32 s25, s25, 98304
    s_waitcnt vmcnt(1)
    buffer_load_dword v166, v5, s[12:15], s25 offen
    s_add_u32 s25, s25, 98304
    s_waitcnt vmcnt(1)
    buffer_load_dword v167, v5, s[12:15], s25 offen
    s_add_u32 s25, s25, 98304
    s_waitcnt vmcnt(1)
    buffer_load_dword v164, v5, s[12:15], s25 offen
    s_add_u32 s25, s25, 98304
    s_waitcnt vmcnt(1)
    v_lshrrev_b32 v1, 4, v0
    v_lshrrev_b32 v2, 1, v1
    v_mul_u32_u24 v2, 20, v2
    v_and_b32 v7, 1, v1
    v_lshl_add_u32 v2, v7, 2, v2
    v_mul_u32_u24 v1, 40, v1
    v_and_b32 v6, 15, v0
    v_lshlrev_b32 v6, 1, v6
    s_movk_i32 s43, 1280
    v_mad_u32_u24 v1, v1, s43, v6
    v_mad_u32_u24 v2, v2, s43, v6
    v_lshlrev_b32 v3, 4, v0
    s_mov_b32 s16, s64
    s_and_b32 s17, s65, 0xffff
    s_mov_b32 s18, 0xc8000
    s_mov_b32 s19, 0x00020000
wof_loop:
    s_add_u32 s45, s42, 0
    s_mul_i32 s26, s45, 3277
    s_lshr_b32 s26, s26, 16
    s_mul_i32 s27, s26, 20
    s_sub_u32 s27, s45, s27
    s_cmp_lt_u32 s27, 16
    s_cselect_b64 s[34:35], -1, 0
    s_movk_i32 s28, 25600
    s_cselect_b32 s28, 10240, s28
    s_mul_i32 s25, s27, 40
    s_mul_i32 s27, s27, 160
    s_sub_u32 s27, s27, 2544
    s_cmp_lg_u64 s[34:35], 0
    s_cselect_b32 s25, s25, s27
    v_cndmask_b32 v5, v1, v2, s[34:35]
    s_mul_i32 s25, s25, 1280
    s_lshl_b32 s26, s26, 5
    s_add_u32 s25, s25, s26
    s_add_u32 s28, s28, s25
    buffer_load_ushort v8, v5, s[16:19], s25 offen offset:0
    buffer_load_ushort v9, v5, s[16:19], s25 offen offset:1280
    buffer_load_ushort v10, v5, s[16:19], s25 offen offset:2560
    buffer_load_ushort v11, v5, s[16:19], s25 offen offset:3840
    buffer_load_ushort v12, v5, s[16:19], s28 offen offset:0
    buffer_load_ushort v13, v5, s[16:19], s28 offen offset:1280
    buffer_load_ushort v14, v5, s[16:19], s28 offen offset:2560
    buffer_load_ushort v15, v5, s[16:19], s28 offen offset:3840
    s_add_u32 s45, s42, 64
    s_mul_i32 s26, s45, 3277
    s_lshr_b32 s26, s26, 16
    s_mul_i32 s27, s26, 20
    s_sub_u32 s27, s45, s27
    s_cmp_lt_u32 s27, 16
    s_cselect_b64 s[34:35], -1, 0
    s_movk_i32 s28, 25600
    s_cselect_b32 s28, 10240, s28
    s_mul_i32 s25, s27, 40
    s_mul_i32 s27, s27, 160
    s_sub_u32 s27, s27, 2544
    s_cmp_lg_u64 s[34:35], 0
    s_cselect_b32 s25, s25, s27
    v_cndmask_b32 v5, v1, v2, s[34:35]
    s_mul_i32 s25, s25, 1280
    s_lshl_b32 s26, s26, 5
    s_add_u32 s25, s25, s26
    s_add_u32 s28, s28, s25
    buffer_load_ushort v20, v5, s[16:19], s25 offen offset:0
    buffer_load_ushort v21, v5, s[16:19], s25 offen offset:1280
    buffer_load_ushort v22, v5, s[16:19], s25 offen offset:2560
    buffer_load_ushort v23, v5, s[16:19], s25 offen offset:3840
    buffer_load_ushort v24, v5, s[16:19], s28 offen offset:0
    buffer_load_ushort v25, v5, s[16:19], s28 offen offset:1280
    buffer_load_ushort v26, v5, s[16:19], s28 offen offset:2560
    buffer_load_ushort v27, v5, s[16:19], s28 offen offset:3840
    s_add_u32 s45, s42, 128
    s_mul_i32 s26, s45, 3277
    s_lshr_b32 s26, s26, 16
    s_mul_i32 s27, s26, 20
    s_sub_u32 s27, s45, s27
    s_cmp_lt_u32 s27, 16
    s_cselect_b64 s[34:35], -1, 0
    s_movk_i32 s28, 25600
    s_cselect_b32 s28, 10240, s28
    s_mul_i32 s25, s27, 40
    s_mul_i32 s27, s27, 160
    s_sub_u32 s27, s27, 2544
    s_cmp_lg_u64 s[34:35], 0
    s_cselect_b32 s25, s25, s27
    v_cndmask_b32 v5, v1, v2, s[34:35]
    s_mul_i32 s25, s25, 1280
    s_lshl_b32 s26, s26, 5
    s_add_u32 s25, s25, s26
    s_add_u32 s28, s28, s25
    buffer_load_ushort v32, v5, s[16:19], s25 offen offset:0
    buffer_load_ushort v33, v5, s[16:19], s25 offen offset:1280
    buffer_load_ushort v34, v5, s[16:19], s25 offen offset:2560
    buffer_load_ushort v35, v5, s[16:19], s25 offen offset:3840
    buffer_load_ushort v36, v5, s[16:19], s28 offen offset:0
    buffer_load_ushort v37, v5, s[16:19], s28 offen offset:1280
    buffer_load_ushort v38, v5, s[16:19], s28 offen offset:2560
    buffer_load_ushort v39, v5, s[16:19], s28 offen offset:3840
    s_add_u32 s45, s42, 192
    s_mul_i32 s26, s45, 3277
    s_lshr_b32 s26, s26, 16
    s_mul_i32 s27, s26, 20
    s_sub_u32 s27, s45, s27
    s_cmp_lt_u32 s27, 16
    s_cselect_b64 s[34:35], -1, 0
    s_movk_i32 s28, 25600
    s_cselect_b32 s28, 10240, s28
    s_mul_i32 s25, s27, 40
    s_mul_i32 s27, s27, 160
    s_sub_u32 s27, s27, 2544
    s_cmp_lg_u64 s[34:35], 0
    s_cselect_b32 s25, s25, s27
    v_cndmask_b32 v5, v1, v2, s[34:35]
    s_mul_i32 s25, s25, 1280
    s_lshl_b32 s26, s26, 5
    s_add_u32 s25, s25, s26
    s_add_u32 s28, s28, s25
    buffer_load_ushort v44, v5, s[16:19], s25 offen offset:0
    buffer_load_ushort v45, v5, s[16:19], s25 offen offset:1280
    buffer_load_ushort v46, v5, s[16:19], s25 offen offset:2560
    buffer_load_ushort v47, v5, s[16:19], s25 offen offset:3840
    buffer_load_ushort v48, v5, s[16:19], s28 offen offset:0
    buffer_load_ushort v49, v5, s[16:19], s28 offen offset:1280
    buffer_load_ushort v50, v5, s[16:19], s28 offen offset:2560
    buffer_load_ushort v51, v5, s[16:19], s28 offen offset:3840
    s_add_u32 s45, s42, 256
    s_mul_i32 s26, s45, 3277
    s_lshr_b32 s26, s26, 16
    s_mul_i32 s27, s26, 20
    s_sub_u32 s27, s45, s27
    s_cmp_lt_u32 s27, 16
    s_cselect_b64 s[34:35], -1, 0
    s_movk_i32 s28, 25600
    s_cselect_b32 s28, 10240, s28
    s_mul_i32 s25, s27, 40
    s_mul_i32 s27, s27, 160
    s_sub_u32 s27, s27, 2544
    s_cmp_lg_u64 s[34:35], 0
    s_cselect_b32 s25, s25, s27
    v_cndmask_b32 v5, v1, v2, s[34:35]
    s_mul_i32 s25, s25, 1280
    s_lshl_b32 s26, s26, 5
    s_add_u32 s25, s25, s26
    s_add_u32 s28, s28, s25
    buffer_load_ushort v56, v5, s[16:19], s25 offen offset:0
    buffer_load_ushort v57, v5, s[16:19], s25 offen offset:1280
    buffer_load_ushort v58, v5, s[16:19], s25 offen offset:2560
    buffer_load_ushort v59, v5, s[16:19], s25 offen offset:3840
    buffer_load_ushort v60, v5, s[16:19], s28 offen offset:0
    buffer_load_ushort v61, v5, s[16:19], s28 offen offset:1280
    buffer_load_ushort v62, v5, s[16:19], s28 offen offset:2560
    buffer_load_ushort v63, v5, s[16:19], s28 offen offset:3840
    s_add_u32 s45, s42, 320
    s_mul_i32 s26, s45, 3277
    s_lshr_b32 s26, s26, 16
    s_mul_i32 s27, s26, 20
    s_sub_u32 s27, s45, s27
    s_cmp_lt_u32 s27, 16
    s_cselect_b64 s[34:35], -1, 0
    s_movk_i32 s28, 25600
    s_cselect_b32 s28, 10240, s28
    s_mul_i32 s25, s27, 40
    s_mul_i32 s27, s27, 160
    s_sub_u32 s27, s27, 2544
    s_cmp_lg_u64 s[34:35], 0
    s_cselect_b32 s25, s25, s27
    v_cndmask_b32 v5, v1, v2, s[34:35]
    s_mul_i32 s25, s25, 1280
    s_lshl_b32 s26, s26, 5
    s_add_u32 s25, s25, s26
    s_add_u32 s28, s28, s25
    buffer_load_ushort v68, v5, s[16:19], s25 offen offset:0
    buffer_load_ushort v69, v5, s[16:19], s25 offen offset:1280
    buffer_load_ushort v70, v5, s[16:19], s25 offen offset:2560
    buffer_load_ushort v71, v5, s[16:19], s25 offen offset:3840
    buffer_load_ushort v72, v5, s[16:19], s28 offen offset:0
    buffer_load_ushort v73, v5, s[16:19], s28 offen offset:1280
    buffer_load_ushort v74, v5, s[16:19], s28 offen offset:2560
    buffer_load_ushort v75, v5, s[16:19], s28 offen offset:3840
    s_add_u32 s45, s42, 384
    s_mul_i32 s26, s45, 3277
    s_lshr_b32 s26, s26, 16
    s_mul_i32 s27, s26, 20
    s_sub_u32 s27, s45, s27
    s_cmp_lt_u32 s27, 16
    s_cselect_b64 s[34:35], -1, 0
    s_movk_i32 s28, 25600
    s_cselect_b32 s28, 10240, s28
    s_mul_i32 s25, s27, 40
    s_mul_i32 s27, s27, 160
    s_sub_u32 s27, s27, 2544
    s_cmp_lg_u64 s[34:35], 0
    s_cselect_b32 s25, s25, s27
    v_cndmask_b32 v5, v1, v2, s[34:35]
    s_mul_i32 s25, s25, 1280
    s_lshl_b32 s26, s26, 5
    s_add_u32 s25, s25, s26
    s_add_u32 s28, s28, s25
    buffer_load_ushort v80, v5, s[16:19], s25 offen offset:0
    buffer_load_ushort v81, v5, s[16:19], s25 offen offset:1280
    buffer_load_ushort v82, v5, s[16:19], s25 offen offset:2560
    buffer_load_ushort v83, v5, s[16:19], s25 offen offset:3840
    buffer_load_ushort v84, v5, s[16:19], s28 offen offset:0
    buffer_load_ushort v85, v5, s[16:19], s28 offen offset:1280
    buffer_load_ushort v86, v5, s[16:19], s28 offen offset:2560
    buffer_load_ushort v87, v5, s[16:19], s28 offen offset:3840
    s_lshl_b32 s25, s42, 10
    s_add_u32 s25, s25, 0xe80000
    s_waitcnt vmcnt(48)
    v_lshl_or_b32 v16, v9, 16, v8
    v_lshl_or_b32 v17, v11, 16, v10
    v_lshl_or_b32 v18, v13, 16, v12
    v_lshl_or_b32 v19, v15, 16, v14
    buffer_store_dwordx4 v[16:19], v3, s[8:11], s25 offen sc1
    s_add_u32 s25, s25, 65536
    s_waitcnt vmcnt(41)
    v_lshl_or_b32 v28, v21, 16, v20
    v_lshl_or_b32 v29, v23, 16, v22
    v_lshl_or_b32 v30, v25, 16, v24
    v_lshl_or_b32 v31, v27, 16, v26
    buffer_store_dwordx4 v[28:31], v3, s[8:11], s25 offen sc1
    s_add_u32 s25, s25, 65536
    s_waitcnt vmcnt(34)
    v_lshl_or_b32 v40, v33, 16, v32
    v_lshl_or_b32 v41, v35, 16, v34
    v_lshl_or_b32 v42, v37, 16, v36
    v_lshl_or_b32 v43, v39, 16, v38
    buffer_store_dwordx4 v[40:43], v3, s[8:11], s25 offen sc1
    s_add_u32 s25, s25, 65536
    s_waitcnt vmcnt(27)
    v_lshl_or_b32 v52, v45, 16, v44
    v_lshl_or_b32 v53, v47, 16, v46
    v_lshl_or_b32 v54, v49, 16, v48
    v_lshl_or_b32 v55, v51, 16, v50
    buffer_store_dwordx4 v[52:55], v3, s[8:11], s25 offen sc1
    s_add_u32 s25, s25, 65536
    s_waitcnt vmcnt(20)
    v_lshl_or_b32 v64, v57, 16, v56
    v_lshl_or_b32 v65, v59, 16, v58
    v_lshl_or_b32 v66, v61, 16, v60
    v_lshl_or_b32 v67, v63, 16, v62
    buffer_store_dwordx4 v[64:67], v3, s[8:11], s25 offen sc1
    s_add_u32 s25, s25, 65536
    s_waitcnt vmcnt(13)
    v_lshl_or_b32 v76, v69, 16, v68
    v_lshl_or_b32 v77, v71, 16, v70
    v_lshl_or_b32 v78, v73, 16, v72
    v_lshl_or_b32 v79, v75, 16, v74
    buffer_store_dwordx4 v[76:79], v3, s[8:11], s25 offen sc1
    s_add_u32 s25, s25, 65536
    s_waitcnt vmcnt(6)
    v_lshl_or_b32 v88, v81, 16, v80
    v_lshl_or_b32 v89, v83, 16, v82
    v_lshl_or_b32 v90, v85, 16, v84
    v_lshl_or_b32 v91, v87, 16, v86
    buffer_store_dwordx4 v[88:91], v3, s[8:11], s25 offen sc1
    s_add_u32 s25, s25, 65536
    s_add_u32 s42, s42, 448
    s_cmp_lt_u32 s42, 800
    s_cbranch_scc1 wof_loop
    s_mov_b32 s28, 0x1201f00
    s_waitcnt vmcnt(0)
    v_mov_b32 v5, 151552
    v_mov_b32 v6, 1
    s_mov_b64 exec, 1
    ds_add_rtn_u32 v7, v5, v6 offset:20
    s_waitcnt lgkmcnt(0)
    v_readfirstlane_b32 s25, v7
    s_cmp_lg_u32 s25, 3
    s_cbranch_scc1 wof_a_nl
    buffer_atomic_add v6, off, s[8:11], s28
wof_a_nl:
    s_mov_b64 exec, -1
    s_mov_b32 s12, s60
    s_and_b32 s13, s61, 0xffff
    s_mov_b32 s14, 0x600000
    s_mov_b32 s15, 0x00020000
    v_lshlrev_b32 v5, 7, v0
    v_min_u32 v5, 8128, v5
    s_and_b32 s25, s44, 3
    s_mul_i32 s25, s25, 384
    s_lshr_b32 s26, s44, 2
    s_lshl_b32 s26, s26, 1
    s_add_u32 s25, s25, s26
    s_add_u32 s25, s25, 128
    s_mul_i32 s25, s25, 4096
    buffer_load_dword v164, v5, s[12:15], s25 offen
    s_add_u32 s25, s25, 131072
    s_waitcnt vmcnt(1)
    buffer_load_dword v165, v5, s[12:15], s25 offen
    s_add_u32 s25, s25, 131072
    s_waitcnt vmcnt(1)
    s_branch m2_go
m1_go:
    s_lshl_b32 s37, s41, 18
    s_lshl_b32 s25, s36, 15
    s_add_u32 s37, s37, s25
    s_add_u32 s37, s37, 0x780000
    s_mul_i32 s38, s36, 1572864
    s_lshl_b32 s25, s40, 7
    s_add_u32 s38, s38, s25
    s_and_b32 s25, s36, 1
    s_lshl_b32 s25, s25, 17
    v_lshl_add_u32 v1, v0, 4, s25
    v_xor_b32 v2, 0x20000, v1
    v_lshrrev_b32 v8, 5, v0
    v_bfe_u32 v6, v0, 2, 2
    v_lshl_add_u32 v7, v8, 2, v6
    v_mul_u32_u24 v7, 3072, v7
    v_bfe_u32 v4, v0, 4, 1
    v_lshl_add_u32 v7, v4, 6, v7
    v_and_b32 v3, 3, v0
    v_lshlrev_b32 v152, 3, v3
    v_lshl_add_u32 v3, v3, 4, v7
    v_lshl_add_u32 v152, v4, 5, v152
    v_lshl_add_u32 v152, v6, 6, v152
    v_lshl_add_u32 v152, v8, 9, v152
    v_add_u32 v4, 23552, v3
    s_lshr_b32 s27, s36, 1
    s_lshl_b32 s27, s27, 8
    s_add_u32 s26, s27, s39
    v_add_u32 v152, s26, v152
    v_xor_b32 v153, 0x100, v152
    v_mov_b32 v136, 0
    v_mov_b32 v137, 0
    v_mov_b32 v138, 0
    v_mov_b32 v139, 0
    s_mov_b32 s12, s56
    s_and_b32 s13, s57, 0xffff
    s_mov_b32 s14, 0x600000
    s_mov_b32 s15, 0x00020000
    v_mfma_f32_32x32x16_bf16 v[24:39], v[136:139], v[136:139], 0
    v_mfma_f32_32x32x16_bf16 v[40:55], v[136:139], v[136:139], 0
    v_mfma_f32_32x32x16_bf16 v[56:71], v[136:139], v[136:139], 0
    s_waitcnt vmcnt(0)
    v_lshlrev_b32 v8, 16, v154
    v_and_b32 v9, 0xffff0000, v154
    v_lshlrev_b32 v10, 16, v155
    v_and_b32 v11, 0xffff0000, v155
    v_lshlrev_b32 v12, 16, v156
    v_and_b32 v13, 0xffff0000, v156
    v_lshlrev_b32 v14, 16, v157
    v_and_b32 v15, 0xffff0000, v157
    v_lshlrev_b32 v16, 16, v158
    v_and_b32 v17, 0xffff0000, v158
    v_lshlrev_b32 v18, 16, v159
    v_and_b32 v19, 0xffff0000, v159
    v_lshlrev_b32 v20, 16, v160
    v_and_b32 v21, 0xffff0000, v160
    v_lshlrev_b32 v22, 16, v161
    v_and_b32 v23, 0xffff0000, v161
    s_and_b32 s25, s24, 0
    s_add_u32 s42, s37, 32768
    s_lshl_b32 s26, s25, 13
    s_add_u32 s37, s37, s26
    s_mul_i32 s26, s25, 393216
    s_add_u32 s38, s38, s26
    v_mov_b32 v5, 151552
m1_hok_spin:
    ds_read_b32 v6, v5 offset:60
    s_waitcnt lgkmcnt(0)
    v_readfirstlane_b32 s25, v6
    s_cmp_ge_u32 s25, 1
    s_cbranch_scc1 m1_hok_done
    s_sleep 4
    s_sub_u32 s68, s68, 1
    s_cbranch_scc0 m1_hok_spin
    s_mov_b32 s68, 0
m1_hok_done:
    v_mov_b32 v5, 151552
m1_p1_spin:
    ds_read_b32 v6, v5 offset:32
    s_waitcnt lgkmcnt(0)
    v_readfirstlane_b32 s25, v6
    s_cmp_ge_u32 s25, 8
    s_cbranch_scc1 m1_p1_done
    s_sleep 4
    s_sub_u32 s68, s68, 1
    s_cbranch_scc0 m1_p1_spin
    s_mov_b32 s68, 0
m1_p1_done:
    s_cmp_lg_u32 s75, 15
    s_cselect_b32 s27, 4, 0
    v_mov_b32 v5, 151552
m1_q_spin:
    ds_read_b32 v6, v5 offset:40
    s_waitcnt lgkmcnt(0)
    v_readfirstlane_b32 s25, v6
    s_cmp_ge_u32 s25, s27
    s_cbranch_scc1 m1_q_done
    s_sleep 2
    s_sub_u32 s68, s68, 1
    s_cbranch_scc0 m1_q_spin
    s_mov_b32 s68, 0
m1_q_done:
    s_mov_b32 m0, s39
    s_setprio 0
    s_nop 0
    buffer_load_dwordx4 v3, s[12:15], s38 offen offset:0 lds
    buffer_load_dwordx4 v4, s[12:15], s38 offen offset:1024 lds
    buffer_load_dwordx4 v[72:75], v1, s[8:11], s37 offen
    buffer_load_dwordx4 v[76:79], v2, s[8:11], s37 offen
    s_add_u32 m0, m0, 2048
    s_add_u32 s37, s37, 1024
    s_add_u32 s38, s38, 49152
    buffer_load_dwordx4 v3, s[12:15], s38 offen offset:0 lds
    buffer_load_dwordx4 v4, s[12:15], s38 offen offset:1024 lds
    buffer_load_dwordx4 v[80:83], v1, s[8:11], s37 offen
    buffer_load_dwordx4 v[84:87], v2, s[8:11], s37 offen
    s_add_u32 m0, m0, 2048
    s_add_u32 s37, s37, 1024
    s_add_u32 s38, s38, 49152
    buffer_load_dwordx4 v3, s[12:15], s38 offen offset:0 lds
    buffer_load_dwordx4 v4, s[12:15], s38 offen offset:1024 lds
    buffer_load_dwordx4 v[88:91], v1, s[8:11], s37 offen
    buffer_load_dwordx4 v[92:95], v2, s[8:11], s37 offen
    s_add_u32 m0, m0, 2048
    s_add_u32 s37, s37, 1024
    s_add_u32 s38, s38, 49152
    buffer_load_dwordx4 v3, s[12:15], s38 offen offset:0 lds
    buffer_load_dwordx4 v4, s[12:15], s38 offen offset:1024 lds
    buffer_load_dwordx4 v[96:99], v1, s[8:11], s37 offen
    buffer_load_dwordx4 v[100:103], v2, s[8:11], s37 offen
    s_add_u32 m0, m0, 2048
    s_add_u32 s37, s37, 1024
    s_add_u32 s38, s38, 49152
    s_cmp_eq_u32 s37, s42
    s_cselect_b32 s25, 32768, 0
    s_cselect_b32 s26, 1572864, 0
    s_sub_u32 s37, s37, s25
    s_sub_u32 s38, s38, s26
    s_waitcnt vmcnt(14)
    ds_read_b64_tr_b16 v[136:137], v152 offset:0
    ds_read_b64_tr_b16 v[138:139], v152 offset:1024
    ds_read_b64_tr_b16 v[140:141], v153 offset:0
    ds_read_b64_tr_b16 v[142:143], v153 offset:1024
    s_mov_b32 s28, 6
    s_setprio 0
m1_loop:
    s_waitcnt vmcnt(10)
    ds_read_b64_tr_b16 v[144:145], v152 offset:2048
    ds_read_b64_tr_b16 v[146:147], v152 offset:3072
    ds_read_b64_tr_b16 v[148:149], v153 offset:2048
    ds_read_b64_tr_b16 v[150:151], v153 offset:3072
    s_add_u32 m0, s39, 0
    s_waitcnt lgkmcnt(4)
    v_mfma_f32_32x32x16_bf16 v[8:23], v[136:139], v[72:75], v[8:23]
    buffer_load_dwordx4 v3, s[12:15], s38 offen offset:0 lds
    v_mfma_f32_32x32x16_bf16 v[40:55], v[140:143], v[72:75], v[40:55]
    buffer_load_dwordx4 v4, s[12:15], s38 offen offset:1024 lds
    v_mfma_f32_32x32x16_bf16 v[24:39], v[136:139], v[76:79], v[24:39]
    buffer_load_dwordx4 v[72:75], v1, s[8:11], s37 offen
    v_mfma_f32_32x32x16_bf16 v[56:71], v[140:143], v[76:79], v[56:71]
    buffer_load_dwordx4 v[76:79], v2, s[8:11], s37 offen
    s_add_u32 s37, s37, 1024
    s_add_u32 s38, s38, 49152
    s_waitcnt vmcnt(10)
    ds_read_b64_tr_b16 v[136:137], v152 offset:4096
    ds_read_b64_tr_b16 v[138:139], v152 offset:5120
    ds_read_b64_tr_b16 v[140:141], v153 offset:4096
    ds_read_b64_tr_b16 v[142:143], v153 offset:5120
    s_add_u32 m0, s39, 2048
    s_waitcnt lgkmcnt(4)
    v_mfma_f32_32x32x16_bf16 v[8:23], v[144:147], v[80:83], v[8:23]
    buffer_load_dwordx4 v3, s[12:15], s38 offen offset:0 lds
    v_mfma_f32_32x32x16_bf16 v[40:55], v[148:151], v[80:83], v[40:55]
    buffer_load_dwordx4 v4, s[12:15], s38 offen offset:1024 lds
    v_mfma_f32_32x32x16_bf16 v[24:39], v[144:147], v[84:87], v[24:39]
    buffer_load_dwordx4 v[80:83], v1, s[8:11], s37 offen
    v_mfma_f32_32x32x16_bf16 v[56:71], v[148:151], v[84:87], v[56:71]
    buffer_load_dwordx4 v[84:87], v2, s[8:11], s37 offen
    s_add_u32 s37, s37, 1024
    s_add_u32 s38, s38, 49152
    s_waitcnt vmcnt(10)
    ds_read_b64_tr_b16 v[144:145], v152 offset:6144
    ds_read_b64_tr_b16 v[146:147], v152 offset:7168
    ds_read_b64_tr_b16 v[148:149], v153 offset:6144
    ds_read_b64_tr_b16 v[150:151], v153 offset:7168
    s_add_u32 m0, s39, 4096
    s_waitcnt lgkmcnt(4)
    v_mfma_f32_32x32x16_bf16 v[8:23], v[136:139], v[88:91], v[8:23]
    buffer_load_dwordx4 v3, s[12:15], s38 offen offset:0 lds
    v_mfma_f32_32x32x16_bf16 v[40:55], v[140:143], v[88:91], v[40:55]
    buffer_load_dwordx4 v4, s[12:15], s38 offen offset:1024 lds
    v_mfma_f32_32x32x16_bf16 v[24:39], v[136:139], v[92:95], v[24:39]
    buffer_load_dwordx4 v[88:91], v1, s[8:11], s37 offen
    v_mfma_f32_32x32x16_bf16 v[56:71], v[140:143], v[92:95], v[56:71]
    buffer_load_dwordx4 v[92:95], v2, s[8:11], s37 offen
    s_add_u32 s37, s37, 1024
    s_add_u32 s38, s38, 49152
    s_waitcnt vmcnt(10)
    ds_read_b64_tr_b16 v[136:137], v152 offset:0
    ds_read_b64_tr_b16 v[138:139], v152 offset:1024
    ds_read_b64_tr_b16 v[140:141], v153 offset:0
    ds_read_b64_tr_b16 v[142:143], v153 offset:1024
    s_add_u32 m0, s39, 6144
    s_waitcnt lgkmcnt(4)
    v_mfma_f32_32x32x16_bf16 v[8:23], v[144:147], v[96:99], v[8:23]
    buffer_load_dwordx4 v3, s[12:15], s38 offen offset:0 lds
    v_mfma_f32_32x32x16_bf16 v[40:55], v[148:151], v[96:99], v[40:55]
    buffer_load_dwordx4 v4, s[12:15], s38 offen offset:1024 lds
    v_mfma_f32_32x32x16_bf16 v[24:39], v[144:147], v[100:103], v[24:39]
    buffer_load_dwordx4 v[96:99], v1, s[8:11], s37 offen
    v_mfma_f32_32x32x16_bf16 v[56:71], v[148:151], v[100:103], v[56:71]
    buffer_load_dwordx4 v[100:103], v2, s[8:11], s37 offen
    s_add_u32 s37, s37, 1024
    s_add_u32 s38, s38, 49152
    s_cmp_eq_u32 s37, s42
    s_cselect_b32 s25, 32768, 0
    s_cselect_b32 s26, 1572864, 0
    s_sub_u32 s37, s37, s25
    s_sub_u32 s38, s38, s26
    s_sub_u32 s28, s28, 1
    s_cbranch_scc0 m1_loop
    s_mov_b32 s16, s60
    s_and_b32 s17, s61, 0xffff
    s_mov_b32 s18, 0x600000
    s_mov_b32 s19, 0x00020000
    v_lshrrev_b32 v5, 1, v0
    v_lshlrev_b32 v5, 12, v5
    v_and_b32 v6, 1, v0
    v_lshl_add_u32 v5, v6, 6, v5
    s_lshr_b32 s25, s23, 1
    s_lshl_b32 s25, s25, 3
    s_and_b32 s26, s24, 7
    s_add_u32 s25, s25, s26
    s_lshl_b32 s25, s25, 7
    s_mul_i32 s26, s36, 1572864
    s_add_u32 s25, s25, s26
    buffer_load_dword v164, v5, s[16:19], s25 offen
    s_add_u32 s25, s25, 131072
    buffer_load_dword v165, v5, s[16:19], s25 offen
    s_add_u32 s25, s25, 131072
    buffer_load_dword v166, v5, s[16:19], s25 offen
    s_add_u32 s25, s25, 131072
    buffer_load_dword v167, v5, s[16:19], s25 offen
    s_add_u32 s25, s25, 131072
    s_waitcnt vmcnt(14)
    ds_read_b64_tr_b16 v[144:145], v152 offset:2048
    ds_read_b64_tr_b16 v[146:147], v152 offset:3072
    ds_read_b64_tr_b16 v[148:149], v153 offset:2048
    ds_read_b64_tr_b16 v[150:151], v153 offset:3072
    s_waitcnt lgkmcnt(4)
    v_mfma_f32_32x32x16_bf16 v[8:23], v[136:139], v[72:75], v[8:23]
    v_mfma_f32_32x32x16_bf16 v[40:55], v[140:143], v[72:75], v[40:55]
    v_mfma_f32_32x32x16_bf16 v[24:39], v[136:139], v[76:79], v[24:39]
    v_mfma_f32_32x32x16_bf16 v[56:71], v[140:143], v[76:79], v[56:71]
    s_waitcnt vmcnt(10)
    ds_read_b64_tr_b16 v[136:137], v152 offset:4096
    ds_read_b64_tr_b16 v[138:139], v152 offset:5120
    ds_read_b64_tr_b16 v[140:141], v153 offset:4096
    ds_read_b64_tr_b16 v[142:143], v153 offset:5120
    s_waitcnt lgkmcnt(4)
    v_mfma_f32_32x32x16_bf16 v[8:23], v[144:147], v[80:83], v[8:23]
    v_mfma_f32_32x32x16_bf16 v[40:55], v[148:151], v[80:83], v[40:55]
    v_mfma_f32_32x32x16_bf16 v[24:39], v[144:147], v[84:87], v[24:39]
    v_mfma_f32_32x32x16_bf16 v[56:71], v[148:151], v[84:87], v[56:71]
    s_waitcnt vmcnt(6)
    ds_read_b64_tr_b16 v[144:145], v152 offset:6144
    ds_read_b64_tr_b16 v[146:147], v152 offset:7168
    ds_read_b64_tr_b16 v[148:149], v153 offset:6144
    ds_read_b64_tr_b16 v[150:151], v153 offset:7168
    s_waitcnt lgkmcnt(4)
    v_mfma_f32_32x32x16_bf16 v[8:23], v[136:139], v[88:91], v[8:23]
    v_mfma_f32_32x32x16_bf16 v[40:55], v[140:143], v[88:91], v[40:55]
    v_mfma_f32_32x32x16_bf16 v[24:39], v[136:139], v[92:95], v[24:39]
    v_mfma_f32_32x32x16_bf16 v[56:71], v[140:143], v[92:95], v[56:71]
    s_waitcnt vmcnt(4) lgkmcnt(0)
    v_mfma_f32_32x32x16_bf16 v[8:23], v[144:147], v[96:99], v[8:23]
    v_mfma_f32_32x32x16_bf16 v[40:55], v[148:151], v[96:99], v[40:55]
    v_mfma_f32_32x32x16_bf16 v[24:39], v[144:147], v[100:103], v[24:39]
    v_mfma_f32_32x32x16_bf16 v[56:71], v[148:151], v[100:103], v[56:71]
    s_setprio 1
    v_lshl_add_u32 v7, v0, 4, s39
    s_nop 7
    s_nop 1
    ds_write_b128 v7, v[40:43] offset:4096
    ds_write_b128 v7, v[44:47] offset:5120
    ds_write_b128 v7, v[48:51] offset:6144
    ds_write_b128 v7, v[52:55] offset:7168
    ds_write_b128 v7, v[24:27] offset:0
    ds_write_b128 v7, v[28:31] offset:1024
    ds_write_b128 v7, v[32:35] offset:2048
    ds_write_b128 v7, v[36:39] offset:3072
    ds_write_b128 v7, v[56:59] offset:8192
    ds_write_b128 v7, v[60:63] offset:9216
    ds_write_b128 v7, v[64:67] offset:10240
    ds_write_b128 v7, v[68:71] offset:11264
    s_waitcnt lgkmcnt(0)
    v_mov_b32 v5, 151552
    v_mov_b32 v6, 1
    s_mov_b64 exec, 1
    ds_add_u32 v5, v6 offset:16
    s_mov_b64 exec, -1
    v_mov_b32 v5, 151552
m1_sg1_spin:
    ds_read_b32 v6, v5 offset:16
    s_waitcnt lgkmcnt(0)
    v_readfirstlane_b32 s25, v6
    s_cmp_ge_u32 s25, 4
    s_cbranch_scc1 m1_sg1_done
    s_sleep 1
    s_sub_u32 s68, s68, 1
    s_cbranch_scc0 m1_sg1_spin
    s_mov_b32 s68, 0
m1_sg1_done:
    s_xor_b32 s25, s36, 1
    s_lshl_b32 s25, s25, 14
    v_lshl_add_u32 v7, v0, 4, s25
    ds_read_b128 v[24:27], v7 offset:0
    ds_read_b128 v[28:31], v7 offset:1024
    ds_read_b128 v[32:35], v7 offset:2048
    ds_read_b128 v[36:39], v7 offset:3072
    s_xor_b32 s25, s36, 2
    s_lshl_b32 s25, s25, 14
    v_lshl_add_u32 v7, v0, 4, s25
    ds_read_b128 v[40:43], v7 offset:4096
    ds_read_b128 v[44:47], v7 offset:5120
    ds_read_b128 v[48:51], v7 offset:6144
    ds_read_b128 v[52:55], v7 offset:7168
    s_xor_b32 s25, s36, 3
    s_lshl_b32 s25, s25, 14
    v_lshl_add_u32 v7, v0, 4, s25
    ds_read_b128 v[56:59], v7 offset:8192
    ds_read_b128 v[60:63], v7 offset:9216
    ds_read_b128 v[64:67], v7 offset:10240
    ds_read_b128 v[68:71], v7 offset:11264
    v_bfe_u32 v4, v0, 4, 1
    v_mul_u32_u24 v4, 49152, v4
    v_lshrrev_b32 v6, 5, v0
    v_lshl_add_u32 v4, v6, 8, v4
    v_and_b32 v6, 15, v0
    v_lshl_add_u32 v4, v6, 4, v4
    v_mov_b32 v7, 0xbdd2d3e8
    s_waitcnt lgkmcnt(8)
    v_add_f32 v8, v8, v24
    v_add_f32 v9, v9, v25
    v_add_f32 v10, v10, v26
    v_add_f32 v11, v11, v27
    v_add_f32 v12, v12, v28
    v_add_f32 v13, v13, v29
    v_add_f32 v14, v14, v30
    v_add_f32 v15, v15, v31
    v_add_f32 v16, v16, v32
    v_add_f32 v17, v17, v33
    v_add_f32 v18, v18, v34
    v_add_f32 v19, v19, v35
    v_add_f32 v20, v20, v36
    v_add_f32 v21, v21, v37
    v_add_f32 v22, v22, v38
    v_add_f32 v23, v23, v39
    s_waitcnt lgkmcnt(4)
    v_add_f32 v8, v8, v40
    v_add_f32 v9, v9, v41
    v_add_f32 v10, v10, v42
    v_add_f32 v11, v11, v43
    v_add_f32 v12, v12, v44
    v_add_f32 v13, v13, v45
    v_add_f32 v14, v14, v46
    v_add_f32 v15, v15, v47
    v_add_f32 v16, v16, v48
    v_add_f32 v17, v17, v49
    v_add_f32 v18, v18, v50
    v_add_f32 v19, v19, v51
    v_add_f32 v20, v20, v52
    v_add_f32 v21, v21, v53
    v_add_f32 v22, v22, v54
    v_add_f32 v23, v23, v55
    s_waitcnt lgkmcnt(0)
    v_add_f32 v8, v8, v56
    v_add_f32 v9, v9, v57
    v_add_f32 v10, v10, v58
    v_add_f32 v11, v11, v59
    v_add_f32 v12, v12, v60
    v_add_f32 v13, v13, v61
    v_add_f32 v14, v14, v62
    v_add_f32 v15, v15, v63
    v_add_f32 v16, v16, v64
    v_add_f32 v17, v17, v65
    v_add_f32 v18, v18, v66
    v_add_f32 v19, v19, v67
    v_add_f32 v20, v20, v68
    v_add_f32 v21, v21, v69
    v_add_f32 v22, v22, v70
    v_add_f32 v23, v23, v71
    v_mov_b32 v5, 151552
    v_mov_b32 v6, 1
    s_mov_b64 exec, 1
    ds_add_u32 v5, v6 offset:16
    s_mov_b64 exec, -1
    v_mul_f32 v72, v8, v8
    v_mul_f32 v73, v9, v9
    v_mul_f32 v74, v10, v10
    v_mul_f32 v75, v11, v11
    v_mul_f32 v76, v12, v12
    v_mul_f32 v77, v13, v13
    v_mul_f32 v78, v14, v14
    v_mul_f32 v79, v15, v15
    v_mul_f32 v80, v16, v16
    v_mul_f32 v81, v17, v17
    v_mul_f32 v82, v18, v18
    v_mul_f32 v83, v19, v19
    v_mul_f32 v84, v20, v20
    v_mul_f32 v85, v21, v21
    v_mul_f32 v86, v22, v22
    v_mul_f32 v87, v23, v23
    v_fmaak_f32 v72, v7, v72, 0xc0135761
    v_fmaak_f32 v73, v7, v73, 0xc0135761
    v_fmaak_f32 v74, v7, v74, 0xc0135761
    v_fmaak_f32 v75, v7, v75, 0xc0135761
    v_fmaak_f32 v76, v7, v76, 0xc0135761
    v_fmaak_f32 v77, v7, v77, 0xc0135761
    v_fmaak_f32 v78, v7, v78, 0xc0135761
    v_fmaak_f32 v79, v7, v79, 0xc0135761
    v_fmaak_f32 v80, v7, v80, 0xc0135761
    v_fmaak_f32 v81, v7, v81, 0xc0135761
    v_fmaak_f32 v82, v7, v82, 0xc0135761
    v_fmaak_f32 v83, v7, v83, 0xc0135761
    v_fmaak_f32 v84, v7, v84, 0xc0135761
    v_fmaak_f32 v85, v7, v85, 0xc0135761
    v_fmaak_f32 v86, v7, v86, 0xc0135761
    v_fmaak_f32 v87, v7, v87, 0xc0135761
    v_mul_f32 v72, v72, v8
    v_mul_f32 v73, v73, v9
    v_mul_f32 v74, v74, v10
    v_mul_f32 v75, v75, v11
    v_mul_f32 v76, v76, v12
    v_mul_f32 v77, v77, v13
    v_mul_f32 v78, v78, v14
    v_mul_f32 v79, v79, v15
    v_mul_f32 v80, v80, v16
    v_mul_f32 v81, v81, v17
    v_mul_f32 v82, v82, v18
    v_mul_f32 v83, v83, v19
    v_mul_f32 v84, v84, v20
    v_mul_f32 v85, v85, v21
    v_mul_f32 v86, v86, v22
    v_mul_f32 v87, v87, v23
    v_exp_f32 v72, v72
    v_exp_f32 v73, v73
    v_exp_f32 v74, v74
    v_exp_f32 v75, v75
    v_exp_f32 v76, v76
    v_exp_f32 v77, v77
    v_exp_f32 v78, v78
    v_exp_f32 v79, v79
    v_exp_f32 v80, v80
    v_exp_f32 v81, v81
    v_exp_f32 v82, v82
    v_exp_f32 v83, v83
    v_exp_f32 v84, v84
    v_exp_f32 v85, v85
    v_exp_f32 v86, v86
    v_exp_f32 v87, v87
    v_add_f32 v72, 1.0, v72
    v_add_f32 v73, 1.0, v73
    v_add_f32 v74, 1.0, v74
    v_add_f32 v75, 1.0, v75
    v_add_f32 v76, 1.0, v76
    v_add_f32 v77, 1.0, v77
    v_add_f32 v78, 1.0, v78
    v_add_f32 v79, 1.0, v79
    v_add_f32 v80, 1.0, v80
    v_add_f32 v81, 1.0, v81
    v_add_f32 v82, 1.0, v82
    v_add_f32 v83, 1.0, v83
    v_add_f32 v84, 1.0, v84
    v_add_f32 v85, 1.0, v85
    v_add_f32 v86, 1.0, v86
    v_add_f32 v87, 1.0, v87
    v_rcp_f32 v72, v72
    v_rcp_f32 v73, v73
    v_rcp_f32 v74, v74
    v_rcp_f32 v75, v75
    v_rcp_f32 v76, v76
    v_rcp_f32 v77, v77
    v_rcp_f32 v78, v78
    v_rcp_f32 v79, v79
    v_rcp_f32 v80, v80
    v_rcp_f32 v81, v81
    v_rcp_f32 v82, v82
    v_rcp_f32 v83, v83
    v_rcp_f32 v84, v84
    v_rcp_f32 v85, v85
    v_rcp_f32 v86, v86
    v_rcp_f32 v87, v87
    v_mul_f32 v8, v8, v72
    v_mul_f32 v9, v9, v73
    v_mul_f32 v10, v10, v74
    v_mul_f32 v11, v11, v75
    v_mul_f32 v12, v12, v76
    v_mul_f32 v13, v13, v77
    v_mul_f32 v14, v14, v78
    v_mul_f32 v15, v15, v79
    v_mul_f32 v16, v16, v80
    v_mul_f32 v17, v17, v81
    v_mul_f32 v18, v18, v82
    v_mul_f32 v19, v19, v83
    v_mul_f32 v20, v20, v84
    v_mul_f32 v21, v21, v85
    v_mul_f32 v22, v22, v86
    v_mul_f32 v23, v23, v87
    v_cvt_pk_bf16_f32 v8, v8, v9
    v_cvt_pk_bf16_f32 v9, v10, v11
    v_cvt_pk_bf16_f32 v10, v12, v13
    v_cvt_pk_bf16_f32 v11, v14, v15
    v_cvt_pk_bf16_f32 v12, v16, v17
    v_cvt_pk_bf16_f32 v13, v18, v19
    v_cvt_pk_bf16_f32 v14, v20, v21
    v_cvt_pk_bf16_f32 v15, v22, v23
    s_lshl_b32 s25, s41, 1
    s_and_b32 s26, s36, 1
    s_add_u32 s25, s25, s26
    s_mul_i32 s25, s25, 96
    s_lshl_b32 s26, s40, 1
    s_add_u32 s25, s25, s26
    s_lshr_b32 s26, s36, 1
    s_add_u32 s25, s25, s26
    s_lshl_b32 s25, s25, 10
    s_add_u32 s25, s25, 0xa00000
    buffer_store_dwordx4 v[8:11], v4, s[8:11], s25 offen offset:0 sc1
    buffer_store_dwordx4 v[12:15], v4, s[8:11], s25 offen offset:512 sc1
    s_mul_i32 s26, s40, 43
    s_lshr_b32 s26, s26, 8
    s_lshl_b32 s25, s41, 2
    s_add_u32 s25, s25, s26
    s_lshl_b32 s25, s25, 8
    s_add_u32 s67, s25, 0x1202000
    v_mov_b32 v5, 151552
m1_sgp_spin:
    ds_read_b32 v6, v5 offset:16
    s_waitcnt lgkmcnt(0)
    v_readfirstlane_b32 s25, v6
    s_cmp_ge_u32 s25, 8
    s_cbranch_scc1 m1_sgp_done
    s_sleep 1
    s_sub_u32 s68, s68, 1
    s_cbranch_scc0 m1_sgp_spin
    s_mov_b32 s68, 0
m1_sgp_done:
    s_mov_b32 s29, 8
m2_go:
    v_mov_b32 v3, v163
    s_lshr_b32 s40, s23, 1
    s_lshl_b32 s40, s40, 3
    s_and_b32 s25, s24, 7
    s_add_u32 s40, s40, s25
    s_mul_i32 s50, s36, 1572864
    s_lshl_b32 s25, s40, 7
    s_add_u32 s50, s50, s25
    s_add_u32 s51, s50, 31744
    s_add_u32 s52, s50, 63488
    s_add_u32 s53, s50, 95232
    v_lshrrev_b32 v5, 5, v0
    v_bfe_u32 v6, v0, 2, 2
    v_lshl_add_u32 v7, v5, 2, v6
    v_lshlrev_b32 v7, 12, v7
    v_bfe_u32 v4, v0, 4, 1
    v_lshl_add_u32 v7, v4, 6, v7
    v_and_b32 v2, 3, v0
    v_lshlrev_b32 v160, 3, v2
    v_lshlrev_b32 v161, 1, v5
    v_xor_b32 v2, v2, v161
    v_lshl_add_u32 v2, v2, 4, v7
    s_mov_b32 s12, s60
    s_and_b32 s13, s61, 0xffff
    s_mov_b32 s14, 0x600000
    s_mov_b32 s15, 0x00020000
    s_setprio 0
    s_setprio 1
    s_cmp_eq_u32 s67, 0
    s_cbranch_scc1 m2_nopub
    v_mov_b32 v8, 1
    s_waitcnt vmcnt(0)
    s_mov_b64 exec, 1
    buffer_atomic_add v8, off, s[8:11], s67
    s_mov_b64 exec, -1
m2_nopub:
    s_setprio 0
    s_add_u32 m0, s39, 0
    s_nop 0
    buffer_load_dwordx4 v2, s[12:15], s50 offen offset:0 lds
    s_add_u32 s50, s50, 131072
    buffer_load_dwordx4 v2, s[12:15], s51 offen offset:1024 lds
    s_add_u32 s51, s51, 131072
    buffer_load_dwordx4 v2, s[12:15], s52 offen offset:2048 lds
    s_add_u32 s52, s52, 131072
    buffer_load_dwordx4 v2, s[12:15], s53 offen offset:3072 lds
    s_add_u32 s53, s53, 131072
    s_add_u32 m0, s39, 4096
    s_nop 0
    buffer_load_dwordx4 v2, s[12:15], s50 offen offset:0 lds
    s_add_u32 s50, s50, 131072
    buffer_load_dwordx4 v2, s[12:15], s51 offen offset:1024 lds
    s_add_u32 s51, s51, 131072
    buffer_load_dwordx4 v2, s[12:15], s52 offen offset:2048 lds
    s_add_u32 s52, s52, 131072
    buffer_load_dwordx4 v2, s[12:15], s53 offen offset:3072 lds
    s_add_u32 s53, s53, 131072
    s_add_u32 m0, s39, 8192
    s_nop 0
    buffer_load_dwordx4 v2, s[12:15], s50 offen offset:0 lds
    s_add_u32 s50, s50, 131072
    buffer_load_dwordx4 v2, s[12:15], s51 offen offset:1024 lds
    s_add_u32 s51, s51, 131072
    buffer_load_dwordx4 v2, s[12:15], s52 offen offset:2048 lds
    s_add_u32 s52, s52, 131072
    buffer_load_dwordx4 v2, s[12:15], s53 offen offset:3072 lds
    s_add_u32 s53, s53, 131072
    s_add_u32 m0, s39, 12288
    s_nop 0
    buffer_load_dwordx4 v2, s[12:15], s50 offen offset:0 lds
    s_add_u32 s50, s50, 131072
    buffer_load_dwordx4 v2, s[12:15], s51 offen offset:1024 lds
    s_add_u32 s51, s51, 131072
    buffer_load_dwordx4 v2, s[12:15], s52 offen offset:2048 lds
    s_add_u32 s52, s52, 131072
    buffer_load_dwordx4 v2, s[12:15], s53 offen offset:3072 lds
    s_add_u32 s53, s53, 131072
    s_setprio 1
    v_lshl_add_u32 v160, v6, 6, v160
    v_lshl_add_u32 v160, v5, 11, v160
    v_lshl_add_u32 v160, v4, 9, v160
    v_lshl_add_u32 v160, v4, 5, v160
    s_lshr_b32 s25, s36, 1
    s_lshl_b32 s25, s25, 8
    s_and_b32 s26, s36, 1
    s_lshl_b32 s26, s26, 5
    s_add_u32 s25, s25, s26
    v_xor_b32 v160, s25, v160
    v_add_u32 v160, s39, v160
    v_xor_b32 v161, 32, v160
    v_xor_b32 v162, 0x100, v160
    v_xor_b32 v163, 0x120, v160
    s_and_b32 s41, s23, 1
    s_lshl_b32 s41, s41, 2
    s_lshr_b32 s25, s24, 3
    s_add_u32 s41, s41, s25
    s_lshl_b32 s25, s25, 18
    v_lshrrev_b32 v5, 1, v0
    v_lshlrev_b32 v5, 12, v5
    v_and_b32 v6, 1, v0
    v_lshl_add_u32 v5, v6, 6, v5
    s_add_u32 s25, s25, s50
    s_add_u32 s26, s25, 131072
    buffer_load_dword v164, v5, s[12:15], s25 offen
    buffer_load_dword v165, v5, s[12:15], s26 offen
    s_mul_i32 s44, s41, 245760
    s_mul_i32 s25, s36, 12288
    s_add_u32 s44, s44, s25
    s_add_u32 s44, s44, 0xa00000
    s_add_u32 s45, s44, 49152
    s_add_u32 s46, s44, 98304
    s_add_u32 s47, s44, 147456
    s_add_u32 s48, s44, 196608
    v_lshlrev_b32 v1, 4, v0
    s_lshl_b32 s25, s40, 2
    s_add_u32 s25, s25, s36
    s_mul_i32 s37, s25, 20480
    s_mul_i32 s26, s41, 160
    s_add_u32 s37, s37, s26
    v_mov_b32 v144, 0
    v_mov_b32 v145, 0
    v_mov_b32 v146, 0
    v_mov_b32 v147, 0
    s_mul_i32 s25, s41, 5
    v_and_b32 v4, 1, v0
    v_lshl_add_u32 v4, v4, 2, s25
    v_and_b32 v4, -4, v4
    v_mfma_f32_32x32x16_bf16 v[8:23], v[144:147], v[144:147], 0
    v_mfma_f32_32x32x16_bf16 v[24:39], v[144:147], v[144:147], 0
    v_mfma_f32_32x32x16_bf16 v[40:55], v[144:147], v[144:147], 0
    v_mfma_f32_32x32x16_bf16 v[56:71], v[144:147], v[144:147], 0
    v_mfma_f32_32x32x16_bf16 v[72:87], v[144:147], v[144:147], 0
    s_add_u32 s25, s36, 32
    v_add_lshl_u32 v4, v4, s25, 8
    v_mov_b32 v7, 7936
    s_mov_b32 s26, 0x1200000
m2_w_poll:
    buffer_load_dword v6, v7, s[8:11], s26 offen sc1
    s_waitcnt vmcnt(0)
    v_cmp_gt_u32 vcc, 16, v6
    s_nop 4
    s_cbranch_vccz m2_w_go
    s_sleep 4
    s_sub_u32 s68, s68, 1
    s_cbranch_scc0 m2_w_poll
    s_mov_b32 s68, 0
m2_w_go:
    s_mov_b32 s26, 0x1200000
m2_u_poll:
    buffer_load_dword v6, v4, s[8:11], s26 offen sc1
    s_waitcnt vmcnt(0)
    v_cmp_gt_u32 vcc, 24, v6
    s_nop 4
    s_cbranch_vccz m2_u_go
    s_sleep 2
    s_sub_u32 s68, s68, 1
    s_cbranch_scc0 m2_u_poll
    s_mov_b32 s68, 0
m2_u_go:
    s_mul_i32 s25, s41, 0
    s_add_u32 s26, s25, 0
    s_mul_i32 s27, s26, 205
    s_lshr_b32 s27, s27, 10
    s_mul_i32 s27, s27, 5
    s_sub_u32 s26, s26, s27
    s_lshl_b32 s42, s26, 10
    s_add_u32 s26, s25, 1
    s_mul_i32 s27, s26, 205
    s_lshr_b32 s27, s27, 10
    s_mul_i32 s27, s27, 5
    s_sub_u32 s26, s26, s27
    s_lshl_b32 s43, s26, 10
    s_add_u32 s26, s25, 2
    s_mul_i32 s27, s26, 205
    s_lshr_b32 s27, s27, 10
    s_mul_i32 s27, s27, 5
    s_sub_u32 s26, s26, s27
    s_lshl_b32 s49, s26, 10
    s_add_u32 s26, s25, 3
    s_mul_i32 s27, s26, 205
    s_lshr_b32 s27, s27, 10
    s_mul_i32 s27, s27, 5
    s_sub_u32 s26, s26, s27
    s_lshl_b32 s66, s26, 10
    s_add_u32 s26, s25, 4
    s_mul_i32 s27, s26, 205
    s_lshr_b32 s27, s27, 10
    s_mul_i32 s27, s27, 5
    s_sub_u32 s26, s26, s27
    s_lshl_b32 s69, s26, 10
    s_setprio 0
    ds_read_b64_tr_b16 v[128:129], v160 offset:0
    ds_read_b64_tr_b16 v[130:131], v160 offset:1024
    ds_read_b64_tr_b16 v[132:133], v161 offset:0
    ds_read_b64_tr_b16 v[134:135], v161 offset:1024
    ds_read_b64_tr_b16 v[136:137], v162 offset:0
    ds_read_b64_tr_b16 v[138:139], v162 offset:1024
    ds_read_b64_tr_b16 v[140:141], v163 offset:0
    ds_read_b64_tr_b16 v[142:143], v163 offset:1024
    buffer_load_dwordx4 v[88:91], v1, s[8:11], s44 offen sc1
    s_add_u32 s44, s44, 1024
    buffer_load_dwordx4 v[92:95], v1, s[8:11], s45 offen sc1
    s_add_u32 s45, s45, 1024
    buffer_load_dwordx4 v[96:99], v1, s[8:11], s46 offen sc1
    s_add_u32 s46, s46, 1024
    buffer_load_dwordx4 v[100:103], v1, s[8:11], s47 offen sc1
    s_add_u32 s47, s47, 1024
    buffer_load_dwordx4 v[104:107], v1, s[8:11], s48 offen sc1
    s_add_u32 s48, s48, 1024
    buffer_load_dwordx4 v[108:111], v1, s[8:11], s44 offen sc1
    s_add_u32 s44, s44, 1024
    buffer_load_dwordx4 v[112:115], v1, s[8:11], s45 offen sc1
    s_add_u32 s45, s45, 1024
    buffer_load_dwordx4 v[116:119], v1, s[8:11], s46 offen sc1
    s_add_u32 s46, s46, 1024
    buffer_load_dwordx4 v[120:123], v1, s[8:11], s47 offen sc1
    s_add_u32 s47, s47, 1024
    buffer_load_dwordx4 v[124:127], v1, s[8:11], s48 offen sc1
    s_add_u32 s48, s48, 1024
    s_mul_i32 s54, s41, 102400
    s_mul_i32 s25, s36, 5120
    s_add_u32 s54, s54, s25
    s_add_u32 s54, s54, 0xe80000
    s_mul_i32 s55, s40, 81920
    s_add_u32 s55, s55, s25
    s_add_u32 s55, s55, 0xc00000
    s_setprio 1
    s_waitcnt lgkmcnt(0)
    s_waitcnt vmcnt(9)
    s_waitcnt vmcnt(20)
    v_mfma_f32_16x16x32_bf16 v[8:11], v[88:91], v[128:131], v[8:11]
    ds_read_b64_tr_b16 v[144:145], v160 offset:4096
    ds_read_b64_tr_b16 v[146:147], v160 offset:5120
    v_mfma_f32_16x16x32_bf16 v[28:31], v[88:91], v[132:135], v[28:31]
    s_add_u32 m0, s39, 0
    s_nop 0
    buffer_load_dwordx4 v2, s[12:15], s50 offen offset:0 lds
    s_add_u32 s50, s50, 131072
    v_mfma_f32_16x16x32_bf16 v[48:51], v[88:91], v[136:139], v[48:51]
    v_mfma_f32_16x16x32_bf16 v[68:71], v[88:91], v[140:143], v[68:71]
    buffer_load_dwordx4 v[88:91], v1, s[8:11], s44 offen sc1
    s_add_u32 s44, s44, 1024
    s_waitcnt vmcnt(10)
    v_mfma_f32_16x16x32_bf16 v[12:15], v[92:95], v[128:131], v[12:15]
    ds_read_b64_tr_b16 v[148:149], v161 offset:4096
    ds_read_b64_tr_b16 v[150:151], v161 offset:5120
    v_mfma_f32_16x16x32_bf16 v[32:35], v[92:95], v[132:135], v[32:35]
    buffer_load_dwordx4 v2, s[12:15], s51 offen offset:1024 lds
    s_add_u32 s51, s51, 131072
    v_mfma_f32_16x16x32_bf16 v[52:55], v[92:95], v[136:139], v[52:55]
    v_mfma_f32_16x16x32_bf16 v[72:75], v[92:95], v[140:143], v[72:75]
    buffer_load_dwordx4 v[92:95], v1, s[8:11], s45 offen sc1
    s_add_u32 s45, s45, 1024
    s_waitcnt vmcnt(11)
    v_mfma_f32_16x16x32_bf16 v[16:19], v[96:99], v[128:131], v[16:19]
    ds_read_b64_tr_b16 v[152:153], v162 offset:4096
    ds_read_b64_tr_b16 v[154:155], v162 offset:5120
    v_mfma_f32_16x16x32_bf16 v[36:39], v[96:99], v[132:135], v[36:39]
    buffer_load_dwordx4 v2, s[12:15], s52 offen offset:2048 lds
    s_add_u32 s52, s52, 131072
    v_mfma_f32_16x16x32_bf16 v[56:59], v[96:99], v[136:139], v[56:59]
    v_mfma_f32_16x16x32_bf16 v[76:79], v[96:99], v[140:143], v[76:79]
    buffer_load_dwordx4 v[96:99], v1, s[8:11], s46 offen sc1
    s_add_u32 s46, s46, 1024
    s_waitcnt vmcnt(12)
    v_mfma_f32_16x16x32_bf16 v[20:23], v[100:103], v[128:131], v[20:23]
    ds_read_b64_tr_b16 v[156:157], v163 offset:4096
    ds_read_b64_tr_b16 v[158:159], v163 offset:5120
    v_mfma_f32_16x16x32_bf16 v[40:43], v[100:103], v[132:135], v[40:43]
    buffer_load_dwordx4 v2, s[12:15], s53 offen offset:3072 lds
    s_add_u32 s53, s53, 131072
    v_mfma_f32_16x16x32_bf16 v[60:63], v[100:103], v[136:139], v[60:63]
    v_mfma_f32_16x16x32_bf16 v[80:83], v[100:103], v[140:143], v[80:83]
    buffer_load_dwordx4 v[100:103], v1, s[8:11], s47 offen sc1
    s_add_u32 s47, s47, 1024
    s_waitcnt vmcnt(13)
    v_mfma_f32_16x16x32_bf16 v[24:27], v[104:107], v[128:131], v[24:27]
    v_mfma_f32_16x16x32_bf16 v[44:47], v[104:107], v[132:135], v[44:47]
    v_mfma_f32_16x16x32_bf16 v[64:67], v[104:107], v[136:139], v[64:67]
    v_mfma_f32_16x16x32_bf16 v[84:87], v[104:107], v[140:143], v[84:87]
    buffer_load_dwordx4 v[104:107], v1, s[8:11], s48 offen sc1
    s_add_u32 s48, s48, 1024
    s_waitcnt lgkmcnt(0)
    s_waitcnt vmcnt(13)
    s_waitcnt vmcnt(25)
    v_mfma_f32_16x16x32_bf16 v[8:11], v[108:111], v[144:147], v[8:11]
    ds_read_b64_tr_b16 v[128:129], v160 offset:8192
    ds_read_b64_tr_b16 v[130:131], v160 offset:9216
    v_mfma_f32_16x16x32_bf16 v[28:31], v[108:111], v[148:151], v[28:31]
    s_add_u32 m0, s39, 4096
    s_nop 0
    buffer_load_dwordx4 v2, s[12:15], s50 offen offset:0 lds
    s_add_u32 s50, s50, 131072
    v_mfma_f32_16x16x32_bf16 v[48:51], v[108:111], v[152:155], v[48:51]
    v_mfma_f32_16x16x32_bf16 v[68:71], v[108:111], v[156:159], v[68:71]
    buffer_load_dwordx4 v[108:111], v1, s[8:11], s44 offen sc1
    s_add_u32 s44, s44, 1024
    s_waitcnt vmcnt(14)
    v_mfma_f32_16x16x32_bf16 v[12:15], v[112:115], v[144:147], v[12:15]
    ds_read_b64_tr_b16 v[132:133], v161 offset:8192
    ds_read_b64_tr_b16 v[134:135], v161 offset:9216
    v_mfma_f32_16x16x32_bf16 v[32:35], v[112:115], v[148:151], v[32:35]
    buffer_load_dwordx4 v2, s[12:15], s51 offen offset:1024 lds
    s_add_u32 s51, s51, 131072
    v_mfma_f32_16x16x32_bf16 v[52:55], v[112:115], v[152:155], v[52:55]
    v_mfma_f32_16x16x32_bf16 v[72:75], v[112:115], v[156:159], v[72:75]
    buffer_load_dwordx4 v[112:115], v1, s[8:11], s45 offen sc1
    s_add_u32 s45, s45, 1024
    s_waitcnt vmcnt(15)
    v_mfma_f32_16x16x32_bf16 v[16:19], v[116:119], v[144:147], v[16:19]
    ds_read_b64_tr_b16 v[136:137], v162 offset:8192
    ds_read_b64_tr_b16 v[138:139], v162 offset:9216
    v_mfma_f32_16x16x32_bf16 v[36:39], v[116:119], v[148:151], v[36:39]
    buffer_load_dwordx4 v2, s[12:15], s52 offen offset:2048 lds
    s_add_u32 s52, s52, 131072
    v_mfma_f32_16x16x32_bf16 v[56:59], v[116:119], v[152:155], v[56:59]
    v_mfma_f32_16x16x32_bf16 v[76:79], v[116:119], v[156:159], v[76:79]
    buffer_load_dwordx4 v[116:119], v1, s[8:11], s46 offen sc1
    s_add_u32 s46, s46, 1024
    s_waitcnt vmcnt(16)
    v_mfma_f32_16x16x32_bf16 v[20:23], v[120:123], v[144:147], v[20:23]
    ds_read_b64_tr_b16 v[140:141], v163 offset:8192
    ds_read_b64_tr_b16 v[142:143], v163 offset:9216
    v_mfma_f32_16x16x32_bf16 v[40:43], v[120:123], v[148:151], v[40:43]
    buffer_load_dwordx4 v2, s[12:15], s53 offen offset:3072 lds
    s_add_u32 s53, s53, 131072
    v_mfma_f32_16x16x32_bf16 v[60:63], v[120:123], v[152:155], v[60:63]
    v_mfma_f32_16x16x32_bf16 v[80:83], v[120:123], v[156:159], v[80:83]
    buffer_load_dwordx4 v[120:123], v1, s[8:11], s47 offen sc1
    s_add_u32 s47, s47, 1024
    s_waitcnt vmcnt(17)
    v_mfma_f32_16x16x32_bf16 v[24:27], v[124:127], v[144:147], v[24:27]
    v_mfma_f32_16x16x32_bf16 v[44:47], v[124:127], v[148:151], v[44:47]
    v_mfma_f32_16x16x32_bf16 v[64:67], v[124:127], v[152:155], v[64:67]
    v_mfma_f32_16x16x32_bf16 v[84:87], v[124:127], v[156:159], v[84:87]
    buffer_load_dwordx4 v[124:127], v1, s[8:11], s48 offen sc1
    s_add_u32 s48, s48, 1024
    s_waitcnt lgkmcnt(0)
    s_waitcnt vmcnt(16)
    s_waitcnt vmcnt(30)
    v_mfma_f32_16x16x32_bf16 v[8:11], v[88:91], v[128:131], v[8:11]
    ds_read_b64_tr_b16 v[144:145], v160 offset:12288
    ds_read_b64_tr_b16 v[146:147], v160 offset:13312
    v_mfma_f32_16x16x32_bf16 v[28:31], v[88:91], v[132:135], v[28:31]
    s_add_u32 m0, s39, 8192
    s_nop 0
    buffer_load_dwordx4 v2, s[12:15], s50 offen offset:0 lds
    s_add_u32 s50, s50, 131072
    v_mfma_f32_16x16x32_bf16 v[48:51], v[88:91], v[136:139], v[48:51]
    v_mfma_f32_16x16x32_bf16 v[68:71], v[88:91], v[140:143], v[68:71]
    buffer_load_dwordx4 v[88:91], v1, s[8:11], s44 offen sc1
    s_add_u32 s44, s44, 1024
    s_waitcnt vmcnt(16)
    v_mfma_f32_16x16x32_bf16 v[12:15], v[92:95], v[128:131], v[12:15]
    ds_read_b64_tr_b16 v[148:149], v161 offset:12288
    ds_read_b64_tr_b16 v[150:151], v161 offset:13312
    v_mfma_f32_16x16x32_bf16 v[32:35], v[92:95], v[132:135], v[32:35]
    buffer_load_dwordx4 v2, s[12:15], s51 offen offset:1024 lds
    s_add_u32 s51, s51, 131072
    v_mfma_f32_16x16x32_bf16 v[52:55], v[92:95], v[136:139], v[52:55]
    v_mfma_f32_16x16x32_bf16 v[72:75], v[92:95], v[140:143], v[72:75]
    buffer_load_dwordx4 v[92:95], v1, s[8:11], s45 offen sc1
    s_add_u32 s45, s45, 1024
    s_waitcnt vmcnt(16)
    v_mfma_f32_16x16x32_bf16 v[16:19], v[96:99], v[128:131], v[16:19]
    ds_read_b64_tr_b16 v[152:153], v162 offset:12288
    ds_read_b64_tr_b16 v[154:155], v162 offset:13312
    v_mfma_f32_16x16x32_bf16 v[36:39], v[96:99], v[132:135], v[36:39]
    buffer_load_dwordx4 v2, s[12:15], s52 offen offset:2048 lds
    s_add_u32 s52, s52, 131072
    v_mfma_f32_16x16x32_bf16 v[56:59], v[96:99], v[136:139], v[56:59]
    v_mfma_f32_16x16x32_bf16 v[76:79], v[96:99], v[140:143], v[76:79]
    buffer_load_dwordx4 v[96:99], v1, s[8:11], s46 offen sc1
    s_add_u32 s46, s46, 1024
    s_waitcnt vmcnt(16)
    v_mfma_f32_16x16x32_bf16 v[20:23], v[100:103], v[128:131], v[20:23]
    ds_read_b64_tr_b16 v[156:157], v163 offset:12288
    ds_read_b64_tr_b16 v[158:159], v163 offset:13312
    v_mfma_f32_16x16x32_bf16 v[40:43], v[100:103], v[132:135], v[40:43]
    buffer_load_dwordx4 v2, s[12:15], s53 offen offset:3072 lds
    s_add_u32 s53, s53, 131072
    v_mfma_f32_16x16x32_bf16 v[60:63], v[100:103], v[136:139], v[60:63]
    v_mfma_f32_16x16x32_bf16 v[80:83], v[100:103], v[140:143], v[80:83]
    buffer_load_dwordx4 v[100:103], v1, s[8:11], s47 offen sc1
    s_add_u32 s47, s47, 1024
    s_waitcnt vmcnt(17)
    v_mfma_f32_16x16x32_bf16 v[24:27], v[104:107], v[128:131], v[24:27]
    v_mfma_f32_16x16x32_bf16 v[44:47], v[104:107], v[132:135], v[44:47]
    v_mfma_f32_16x16x32_bf16 v[64:67], v[104:107], v[136:139], v[64:67]
    v_mfma_f32_16x16x32_bf16 v[84:87], v[104:107], v[140:143], v[84:87]
    buffer_load_dwordx4 v[104:107], v1, s[8:11], s48 offen sc1
    s_add_u32 s48, s48, 1024
    s_waitcnt lgkmcnt(0)
    s_waitcnt vmcnt(16)
    s_waitcnt vmcnt(20)
    v_mfma_f32_16x16x32_bf16 v[8:11], v[108:111], v[144:147], v[8:11]
    ds_read_b64_tr_b16 v[128:129], v160 offset:0
    ds_read_b64_tr_b16 v[130:131], v160 offset:1024
    v_mfma_f32_16x16x32_bf16 v[28:31], v[108:111], v[148:151], v[28:31]
    s_add_u32 m0, s39, 12288
    s_nop 0
    buffer_load_dwordx4 v2, s[12:15], s50 offen offset:0 lds
    s_add_u32 s50, s50, 131072
    v_mfma_f32_16x16x32_bf16 v[48:51], v[108:111], v[152:155], v[48:51]
    v_mfma_f32_16x16x32_bf16 v[68:71], v[108:111], v[156:159], v[68:71]
    buffer_load_dwordx4 v[108:111], v1, s[8:11], s44 offen sc1
    s_add_u32 s44, s44, 1024
    s_waitcnt vmcnt(16)
    v_mfma_f32_16x16x32_bf16 v[12:15], v[112:115], v[144:147], v[12:15]
    ds_read_b64_tr_b16 v[132:133], v161 offset:0
    ds_read_b64_tr_b16 v[134:135], v161 offset:1024
    v_mfma_f32_16x16x32_bf16 v[32:35], v[112:115], v[148:151], v[32:35]
    buffer_load_dwordx4 v2, s[12:15], s51 offen offset:1024 lds
    s_add_u32 s51, s51, 131072
    v_mfma_f32_16x16x32_bf16 v[52:55], v[112:115], v[152:155], v[52:55]
    v_mfma_f32_16x16x32_bf16 v[72:75], v[112:115], v[156:159], v[72:75]
    buffer_load_dwordx4 v[112:115], v1, s[8:11], s45 offen sc1
    s_add_u32 s45, s45, 1024
    s_waitcnt vmcnt(16)
    v_mfma_f32_16x16x32_bf16 v[16:19], v[116:119], v[144:147], v[16:19]
    ds_read_b64_tr_b16 v[136:137], v162 offset:0
    ds_read_b64_tr_b16 v[138:139], v162 offset:1024
    v_mfma_f32_16x16x32_bf16 v[36:39], v[116:119], v[148:151], v[36:39]
    buffer_load_dwordx4 v2, s[12:15], s52 offen offset:2048 lds
    s_add_u32 s52, s52, 131072
    v_mfma_f32_16x16x32_bf16 v[56:59], v[116:119], v[152:155], v[56:59]
    v_mfma_f32_16x16x32_bf16 v[76:79], v[116:119], v[156:159], v[76:79]
    buffer_load_dwordx4 v[116:119], v1, s[8:11], s46 offen sc1
    s_add_u32 s46, s46, 1024
    s_waitcnt vmcnt(16)
    v_mfma_f32_16x16x32_bf16 v[20:23], v[120:123], v[144:147], v[20:23]
    ds_read_b64_tr_b16 v[140:141], v163 offset:0
    ds_read_b64_tr_b16 v[142:143], v163 offset:1024
    v_mfma_f32_16x16x32_bf16 v[40:43], v[120:123], v[148:151], v[40:43]
    buffer_load_dwordx4 v2, s[12:15], s53 offen offset:3072 lds
    s_add_u32 s53, s53, 131072
    v_mfma_f32_16x16x32_bf16 v[60:63], v[120:123], v[152:155], v[60:63]
    v_mfma_f32_16x16x32_bf16 v[80:83], v[120:123], v[156:159], v[80:83]
    buffer_load_dwordx4 v[120:123], v1, s[8:11], s47 offen sc1
    s_add_u32 s47, s47, 1024
    s_waitcnt vmcnt(17)
    v_mfma_f32_16x16x32_bf16 v[24:27], v[124:127], v[144:147], v[24:27]
    v_mfma_f32_16x16x32_bf16 v[44:47], v[124:127], v[148:151], v[44:47]
    v_mfma_f32_16x16x32_bf16 v[64:67], v[124:127], v[152:155], v[64:67]
    v_mfma_f32_16x16x32_bf16 v[84:87], v[124:127], v[156:159], v[84:87]
    buffer_load_dwordx4 v[124:127], v1, s[8:11], s48 offen sc1
    s_add_u32 s48, s48, 1024
    s_waitcnt lgkmcnt(0)
    s_waitcnt vmcnt(16)
    s_waitcnt vmcnt(20)
    v_mfma_f32_16x16x32_bf16 v[8:11], v[88:91], v[128:131], v[8:11]
    ds_read_b64_tr_b16 v[144:145], v160 offset:4096
    ds_read_b64_tr_b16 v[146:147], v160 offset:5120
    v_mfma_f32_16x16x32_bf16 v[28:31], v[88:91], v[132:135], v[28:31]
    s_add_u32 m0, s39, 0
    s_nop 0
    buffer_load_dwordx4 v2, s[12:15], s50 offen offset:0 lds
    s_add_u32 s50, s50, 131072
    v_mfma_f32_16x16x32_bf16 v[48:51], v[88:91], v[136:139], v[48:51]
    v_mfma_f32_16x16x32_bf16 v[68:71], v[88:91], v[140:143], v[68:71]
    buffer_load_dwordx4 v[88:91], v1, s[8:11], s44 offen sc1
    s_add_u32 s44, s44, 1024
    s_waitcnt vmcnt(16)
    v_mfma_f32_16x16x32_bf16 v[12:15], v[92:95], v[128:131], v[12:15]
    ds_read_b64_tr_b16 v[148:149], v161 offset:4096
    ds_read_b64_tr_b16 v[150:151], v161 offset:5120
    v_mfma_f32_16x16x32_bf16 v[32:35], v[92:95], v[132:135], v[32:35]
    buffer_load_dwordx4 v2, s[12:15], s51 offen offset:1024 lds
    s_add_u32 s51, s51, 131072
    v_mfma_f32_16x16x32_bf16 v[52:55], v[92:95], v[136:139], v[52:55]
    v_mfma_f32_16x16x32_bf16 v[72:75], v[92:95], v[140:143], v[72:75]
    buffer_load_dwordx4 v[92:95], v1, s[8:11], s45 offen sc1
    s_add_u32 s45, s45, 1024
    s_waitcnt vmcnt(16)
    v_mfma_f32_16x16x32_bf16 v[16:19], v[96:99], v[128:131], v[16:19]
    ds_read_b64_tr_b16 v[152:153], v162 offset:4096
    ds_read_b64_tr_b16 v[154:155], v162 offset:5120
    v_mfma_f32_16x16x32_bf16 v[36:39], v[96:99], v[132:135], v[36:39]
    buffer_load_dwordx4 v2, s[12:15], s52 offen offset:2048 lds
    s_add_u32 s52, s52, 131072
    v_mfma_f32_16x16x32_bf16 v[56:59], v[96:99], v[136:139], v[56:59]
    v_mfma_f32_16x16x32_bf16 v[76:79], v[96:99], v[140:143], v[76:79]
    buffer_load_dwordx4 v[96:99], v1, s[8:11], s46 offen sc1
    s_add_u32 s46, s46, 1024
    s_waitcnt vmcnt(16)
    v_mfma_f32_16x16x32_bf16 v[20:23], v[100:103], v[128:131], v[20:23]
    ds_read_b64_tr_b16 v[156:157], v163 offset:4096
    ds_read_b64_tr_b16 v[158:159], v163 offset:5120
    v_mfma_f32_16x16x32_bf16 v[40:43], v[100:103], v[132:135], v[40:43]
    buffer_load_dwordx4 v2, s[12:15], s53 offen offset:3072 lds
    s_add_u32 s53, s53, 131072
    v_mfma_f32_16x16x32_bf16 v[60:63], v[100:103], v[136:139], v[60:63]
    v_mfma_f32_16x16x32_bf16 v[80:83], v[100:103], v[140:143], v[80:83]
    buffer_load_dwordx4 v[100:103], v1, s[8:11], s47 offen sc1
    s_add_u32 s47, s47, 1024
    s_waitcnt vmcnt(17)
    v_mfma_f32_16x16x32_bf16 v[24:27], v[104:107], v[128:131], v[24:27]
    v_mfma_f32_16x16x32_bf16 v[44:47], v[104:107], v[132:135], v[44:47]
    v_mfma_f32_16x16x32_bf16 v[64:67], v[104:107], v[136:139], v[64:67]
    v_mfma_f32_16x16x32_bf16 v[84:87], v[104:107], v[140:143], v[84:87]
    buffer_load_dwordx4 v[104:107], v1, s[8:11], s48 offen sc1
    s_add_u32 s48, s48, 1024
    s_waitcnt lgkmcnt(0)
    s_waitcnt vmcnt(16)
    s_waitcnt vmcnt(20)
    v_mfma_f32_16x16x32_bf16 v[8:11], v[108:111], v[144:147], v[8:11]
    ds_read_b64_tr_b16 v[128:129], v160 offset:8192
    ds_read_b64_tr_b16 v[130:131], v160 offset:9216
    v_mfma_f32_16x16x32_bf16 v[28:31], v[108:111], v[148:151], v[28:31]
    s_add_u32 m0, s39, 4096
    s_nop 0
    buffer_load_dwordx4 v2, s[12:15], s50 offen offset:0 lds
    s_add_u32 s50, s50, 131072
    v_mfma_f32_16x16x32_bf16 v[48:51], v[108:111], v[152:155], v[48:51]
    v_mfma_f32_16x16x32_bf16 v[68:71], v[108:111], v[156:159], v[68:71]
    buffer_load_dwordx4 v[108:111], v1, s[8:11], s44 offen sc1
    s_add_u32 s44, s44, 1024
    s_waitcnt vmcnt(16)
    v_mfma_f32_16x16x32_bf16 v[12:15], v[112:115], v[144:147], v[12:15]
    ds_read_b64_tr_b16 v[132:133], v161 offset:8192
    ds_read_b64_tr_b16 v[134:135], v161 offset:9216
    v_mfma_f32_16x16x32_bf16 v[32:35], v[112:115], v[148:151], v[32:35]
    buffer_load_dwordx4 v2, s[12:15], s51 offen offset:1024 lds
    s_add_u32 s51, s51, 131072
    v_mfma_f32_16x16x32_bf16 v[52:55], v[112:115], v[152:155], v[52:55]
    v_mfma_f32_16x16x32_bf16 v[72:75], v[112:115], v[156:159], v[72:75]
    buffer_load_dwordx4 v[112:115], v1, s[8:11], s45 offen sc1
    s_add_u32 s45, s45, 1024
    s_waitcnt vmcnt(16)
    v_mfma_f32_16x16x32_bf16 v[16:19], v[116:119], v[144:147], v[16:19]
    ds_read_b64_tr_b16 v[136:137], v162 offset:8192
    ds_read_b64_tr_b16 v[138:139], v162 offset:9216
    v_mfma_f32_16x16x32_bf16 v[36:39], v[116:119], v[148:151], v[36:39]
    buffer_load_dwordx4 v2, s[12:15], s52 offen offset:2048 lds
    s_add_u32 s52, s52, 131072
    v_mfma_f32_16x16x32_bf16 v[56:59], v[116:119], v[152:155], v[56:59]
    v_mfma_f32_16x16x32_bf16 v[76:79], v[116:119], v[156:159], v[76:79]
    buffer_load_dwordx4 v[116:119], v1, s[8:11], s46 offen sc1
    s_add_u32 s46, s46, 1024
    s_waitcnt vmcnt(16)
    v_mfma_f32_16x16x32_bf16 v[20:23], v[120:123], v[144:147], v[20:23]
    ds_read_b64_tr_b16 v[140:141], v163 offset:8192
    ds_read_b64_tr_b16 v[142:143], v163 offset:9216
    v_mfma_f32_16x16x32_bf16 v[40:43], v[120:123], v[148:151], v[40:43]
    buffer_load_dwordx4 v2, s[12:15], s53 offen offset:3072 lds
    s_add_u32 s53, s53, 131072
    v_mfma_f32_16x16x32_bf16 v[60:63], v[120:123], v[152:155], v[60:63]
    v_mfma_f32_16x16x32_bf16 v[80:83], v[120:123], v[156:159], v[80:83]
    buffer_load_dwordx4 v[120:123], v1, s[8:11], s47 offen sc1
    s_add_u32 s47, s47, 1024
    s_waitcnt vmcnt(17)
    v_mfma_f32_16x16x32_bf16 v[24:27], v[124:127], v[144:147], v[24:27]
    v_mfma_f32_16x16x32_bf16 v[44:47], v[124:127], v[148:151], v[44:47]
    v_mfma_f32_16x16x32_bf16 v[64:67], v[124:127], v[152:155], v[64:67]
    v_mfma_f32_16x16x32_bf16 v[84:87], v[124:127], v[156:159], v[84:87]
    buffer_load_dwordx4 v[124:127], v1, s[8:11], s48 offen sc1
    s_add_u32 s48, s48, 1024
    s_waitcnt lgkmcnt(0)
    s_waitcnt vmcnt(16)
    s_waitcnt vmcnt(20)
    v_mfma_f32_16x16x32_bf16 v[8:11], v[88:91], v[128:131], v[8:11]
    ds_read_b64_tr_b16 v[144:145], v160 offset:12288
    ds_read_b64_tr_b16 v[146:147], v160 offset:13312
    v_mfma_f32_16x16x32_bf16 v[28:31], v[88:91], v[132:135], v[28:31]
    s_add_u32 m0, s39, 8192
    s_nop 0
    buffer_load_dwordx4 v2, s[12:15], s50 offen offset:0 lds
    s_add_u32 s50, s50, 131072
    v_mfma_f32_16x16x32_bf16 v[48:51], v[88:91], v[136:139], v[48:51]
    v_mfma_f32_16x16x32_bf16 v[68:71], v[88:91], v[140:143], v[68:71]
    buffer_load_dwordx4 v[88:91], v1, s[8:11], s44 offen sc1
    s_add_u32 s44, s44, 1024
    s_waitcnt vmcnt(16)
    v_mfma_f32_16x16x32_bf16 v[12:15], v[92:95], v[128:131], v[12:15]
    ds_read_b64_tr_b16 v[148:149], v161 offset:12288
    ds_read_b64_tr_b16 v[150:151], v161 offset:13312
    v_mfma_f32_16x16x32_bf16 v[32:35], v[92:95], v[132:135], v[32:35]
    buffer_load_dwordx4 v2, s[12:15], s51 offen offset:1024 lds
    s_add_u32 s51, s51, 131072
    v_mfma_f32_16x16x32_bf16 v[52:55], v[92:95], v[136:139], v[52:55]
    v_mfma_f32_16x16x32_bf16 v[72:75], v[92:95], v[140:143], v[72:75]
    buffer_load_dwordx4 v[92:95], v1, s[8:11], s45 offen sc1
    s_add_u32 s45, s45, 1024
    s_waitcnt vmcnt(16)
    v_mfma_f32_16x16x32_bf16 v[16:19], v[96:99], v[128:131], v[16:19]
    ds_read_b64_tr_b16 v[152:153], v162 offset:12288
    ds_read_b64_tr_b16 v[154:155], v162 offset:13312
    v_mfma_f32_16x16x32_bf16 v[36:39], v[96:99], v[132:135], v[36:39]
    buffer_load_dwordx4 v2, s[12:15], s52 offen offset:2048 lds
    s_add_u32 s52, s52, 131072
    v_mfma_f32_16x16x32_bf16 v[56:59], v[96:99], v[136:139], v[56:59]
    v_mfma_f32_16x16x32_bf16 v[76:79], v[96:99], v[140:143], v[76:79]
    buffer_load_dwordx4 v[96:99], v1, s[8:11], s46 offen sc1
    s_add_u32 s46, s46, 1024
    s_waitcnt vmcnt(16)
    v_mfma_f32_16x16x32_bf16 v[20:23], v[100:103], v[128:131], v[20:23]
    ds_read_b64_tr_b16 v[156:157], v163 offset:12288
    ds_read_b64_tr_b16 v[158:159], v163 offset:13312
    v_mfma_f32_16x16x32_bf16 v[40:43], v[100:103], v[132:135], v[40:43]
    buffer_load_dwordx4 v2, s[12:15], s53 offen offset:3072 lds
    s_add_u32 s53, s53, 131072
    v_mfma_f32_16x16x32_bf16 v[60:63], v[100:103], v[136:139], v[60:63]
    v_mfma_f32_16x16x32_bf16 v[80:83], v[100:103], v[140:143], v[80:83]
    buffer_load_dwordx4 v[100:103], v1, s[8:11], s47 offen sc1
    s_add_u32 s47, s47, 1024
    s_waitcnt vmcnt(17)
    v_mfma_f32_16x16x32_bf16 v[24:27], v[104:107], v[128:131], v[24:27]
    v_mfma_f32_16x16x32_bf16 v[44:47], v[104:107], v[132:135], v[44:47]
    v_mfma_f32_16x16x32_bf16 v[64:67], v[104:107], v[136:139], v[64:67]
    v_mfma_f32_16x16x32_bf16 v[84:87], v[104:107], v[140:143], v[84:87]
    buffer_load_dwordx4 v[104:107], v1, s[8:11], s48 offen sc1
    s_add_u32 s48, s48, 1024
    s_waitcnt lgkmcnt(0)
    s_waitcnt vmcnt(16)
    s_waitcnt vmcnt(20)
    v_mfma_f32_16x16x32_bf16 v[8:11], v[108:111], v[144:147], v[8:11]
    ds_read_b64_tr_b16 v[128:129], v160 offset:0
    ds_read_b64_tr_b16 v[130:131], v160 offset:1024
    v_mfma_f32_16x16x32_bf16 v[28:31], v[108:111], v[148:151], v[28:31]
    s_add_u32 m0, s39, 12288
    s_nop 0
    buffer_load_dwordx4 v2, s[12:15], s50 offen offset:0 lds
    s_add_u32 s50, s50, 131072
    v_mfma_f32_16x16x32_bf16 v[48:51], v[108:111], v[152:155], v[48:51]
    v_mfma_f32_16x16x32_bf16 v[68:71], v[108:111], v[156:159], v[68:71]
    buffer_load_dwordx4 v[108:111], v1, s[8:11], s44 offen sc1
    s_add_u32 s44, s44, 1024
    s_waitcnt vmcnt(16)
    v_mfma_f32_16x16x32_bf16 v[12:15], v[112:115], v[144:147], v[12:15]
    ds_read_b64_tr_b16 v[132:133], v161 offset:0
    ds_read_b64_tr_b16 v[134:135], v161 offset:1024
    v_mfma_f32_16x16x32_bf16 v[32:35], v[112:115], v[148:151], v[32:35]
    buffer_load_dwordx4 v2, s[12:15], s51 offen offset:1024 lds
    s_add_u32 s51, s51, 131072
    v_mfma_f32_16x16x32_bf16 v[52:55], v[112:115], v[152:155], v[52:55]
    v_mfma_f32_16x16x32_bf16 v[72:75], v[112:115], v[156:159], v[72:75]
    buffer_load_dwordx4 v[112:115], v1, s[8:11], s45 offen sc1
    s_add_u32 s45, s45, 1024
    s_waitcnt vmcnt(16)
    v_mfma_f32_16x16x32_bf16 v[16:19], v[116:119], v[144:147], v[16:19]
    ds_read_b64_tr_b16 v[136:137], v162 offset:0
    ds_read_b64_tr_b16 v[138:139], v162 offset:1024
    v_mfma_f32_16x16x32_bf16 v[36:39], v[116:119], v[148:151], v[36:39]
    buffer_load_dwordx4 v2, s[12:15], s52 offen offset:2048 lds
    s_add_u32 s52, s52, 131072
    v_mfma_f32_16x16x32_bf16 v[56:59], v[116:119], v[152:155], v[56:59]
    v_mfma_f32_16x16x32_bf16 v[76:79], v[116:119], v[156:159], v[76:79]
    buffer_load_dwordx4 v[116:119], v1, s[8:11], s46 offen sc1
    s_add_u32 s46, s46, 1024
    s_waitcnt vmcnt(16)
    v_mfma_f32_16x16x32_bf16 v[20:23], v[120:123], v[144:147], v[20:23]
    ds_read_b64_tr_b16 v[140:141], v163 offset:0
    ds_read_b64_tr_b16 v[142:143], v163 offset:1024
    v_mfma_f32_16x16x32_bf16 v[40:43], v[120:123], v[148:151], v[40:43]
    buffer_load_dwordx4 v2, s[12:15], s53 offen offset:3072 lds
    s_add_u32 s53, s53, 131072
    v_mfma_f32_16x16x32_bf16 v[60:63], v[120:123], v[152:155], v[60:63]
    v_mfma_f32_16x16x32_bf16 v[80:83], v[120:123], v[156:159], v[80:83]
    buffer_load_dwordx4 v[120:123], v1, s[8:11], s47 offen sc1
    s_add_u32 s47, s47, 1024
    s_waitcnt vmcnt(17)
    v_mfma_f32_16x16x32_bf16 v[24:27], v[124:127], v[144:147], v[24:27]
    v_mfma_f32_16x16x32_bf16 v[44:47], v[124:127], v[148:151], v[44:47]
    v_mfma_f32_16x16x32_bf16 v[64:67], v[124:127], v[152:155], v[64:67]
    v_mfma_f32_16x16x32_bf16 v[84:87], v[124:127], v[156:159], v[84:87]
    buffer_load_dwordx4 v[124:127], v1, s[8:11], s48 offen sc1
    s_add_u32 s48, s48, 1024
    s_waitcnt lgkmcnt(0)
    s_waitcnt vmcnt(16)
    s_waitcnt vmcnt(20)
    v_mfma_f32_16x16x32_bf16 v[8:11], v[88:91], v[128:131], v[8:11]
    ds_read_b64_tr_b16 v[144:145], v160 offset:4096
    ds_read_b64_tr_b16 v[146:147], v160 offset:5120
    v_mfma_f32_16x16x32_bf16 v[28:31], v[88:91], v[132:135], v[28:31]
    s_add_u32 m0, s39, 0
    s_add_u32 s25, s54, s42
    buffer_load_dwordx4 v1, s[8:11], s25 offen sc1 lds
    v_mfma_f32_16x16x32_bf16 v[48:51], v[88:91], v[136:139], v[48:51]
    v_mfma_f32_16x16x32_bf16 v[68:71], v[88:91], v[140:143], v[68:71]
    buffer_load_dwordx4 v[88:91], v1, s[8:11], s44 offen sc1
    s_add_u32 s44, s44, 1024
    s_waitcnt vmcnt(16)
    v_mfma_f32_16x16x32_bf16 v[12:15], v[92:95], v[128:131], v[12:15]
    ds_read_b64_tr_b16 v[148:149], v161 offset:4096
    ds_read_b64_tr_b16 v[150:151], v161 offset:5120
    v_mfma_f32_16x16x32_bf16 v[32:35], v[92:95], v[132:135], v[32:35]
    s_add_u32 m0, s39, 1024
    s_add_u32 s25, s54, s42
    s_add_u32 s25, s25, 20480
    buffer_load_dwordx4 v1, s[8:11], s25 offen sc1 lds
    v_mfma_f32_16x16x32_bf16 v[52:55], v[92:95], v[136:139], v[52:55]
    v_mfma_f32_16x16x32_bf16 v[72:75], v[92:95], v[140:143], v[72:75]
    buffer_load_dwordx4 v[92:95], v1, s[8:11], s45 offen sc1
    s_add_u32 s45, s45, 1024
    s_waitcnt vmcnt(16)
    v_mfma_f32_16x16x32_bf16 v[16:19], v[96:99], v[128:131], v[16:19]
    ds_read_b64_tr_b16 v[152:153], v162 offset:4096
    ds_read_b64_tr_b16 v[154:155], v162 offset:5120
    v_mfma_f32_16x16x32_bf16 v[36:39], v[96:99], v[132:135], v[36:39]
    s_add_u32 m0, s39, 2048
    s_add_u32 s25, s54, s42
    s_add_u32 s25, s25, 40960
    buffer_load_dwordx4 v1, s[8:11], s25 offen sc1 lds
    v_mfma_f32_16x16x32_bf16 v[56:59], v[96:99], v[136:139], v[56:59]
    v_mfma_f32_16x16x32_bf16 v[76:79], v[96:99], v[140:143], v[76:79]
    buffer_load_dwordx4 v[96:99], v1, s[8:11], s46 offen sc1
    s_add_u32 s46, s46, 1024
    s_waitcnt vmcnt(16)
    v_mfma_f32_16x16x32_bf16 v[20:23], v[100:103], v[128:131], v[20:23]
    ds_read_b64_tr_b16 v[156:157], v163 offset:4096
    ds_read_b64_tr_b16 v[158:159], v163 offset:5120
    v_mfma_f32_16x16x32_bf16 v[40:43], v[100:103], v[132:135], v[40:43]
    s_add_u32 m0, s39, 3072
    s_add_u32 s25, s54, s42
    s_add_u32 s25, s25, 61440
    buffer_load_dwordx4 v1, s[8:11], s25 offen sc1 lds
    v_mfma_f32_16x16x32_bf16 v[60:63], v[100:103], v[136:139], v[60:63]
    v_mfma_f32_16x16x32_bf16 v[80:83], v[100:103], v[140:143], v[80:83]
    buffer_load_dwordx4 v[100:103], v1, s[8:11], s47 offen sc1
    s_add_u32 s47, s47, 1024
    s_waitcnt vmcnt(17)
    v_mfma_f32_16x16x32_bf16 v[24:27], v[104:107], v[128:131], v[24:27]
    v_mfma_f32_16x16x32_bf16 v[44:47], v[104:107], v[132:135], v[44:47]
    v_mfma_f32_16x16x32_bf16 v[64:67], v[104:107], v[136:139], v[64:67]
    v_mfma_f32_16x16x32_bf16 v[84:87], v[104:107], v[140:143], v[84:87]
    buffer_load_dwordx4 v[104:107], v1, s[8:11], s48 offen sc1
    s_add_u32 s48, s48, 1024
    s_waitcnt lgkmcnt(0)
    s_waitcnt vmcnt(16)
    s_waitcnt vmcnt(20)
    v_mfma_f32_16x16x32_bf16 v[8:11], v[108:111], v[144:147], v[8:11]
    ds_read_b64_tr_b16 v[128:129], v160 offset:8192
    ds_read_b64_tr_b16 v[130:131], v160 offset:9216
    v_mfma_f32_16x16x32_bf16 v[28:31], v[108:111], v[148:151], v[28:31]
    s_add_u32 m0, s39, 4096
    s_add_u32 s25, s54, s42
    s_add_u32 s25, s25, 81920
    buffer_load_dwordx4 v1, s[8:11], s25 offen sc1 lds
    v_mfma_f32_16x16x32_bf16 v[48:51], v[108:111], v[152:155], v[48:51]
    v_mfma_f32_16x16x32_bf16 v[68:71], v[108:111], v[156:159], v[68:71]
    buffer_load_dwordx4 v[108:111], v1, s[8:11], s44 offen sc1
    s_add_u32 s44, s44, 1024
    s_waitcnt vmcnt(16)
    v_mfma_f32_16x16x32_bf16 v[12:15], v[112:115], v[144:147], v[12:15]
    ds_read_b64_tr_b16 v[132:133], v161 offset:8192
    ds_read_b64_tr_b16 v[134:135], v161 offset:9216
    v_mfma_f32_16x16x32_bf16 v[32:35], v[112:115], v[148:151], v[32:35]
    s_add_u32 m0, s39, 5120
    s_add_u32 s25, s54, s43
    buffer_load_dwordx4 v1, s[8:11], s25 offen sc1 lds
    v_mfma_f32_16x16x32_bf16 v[52:55], v[112:115], v[152:155], v[52:55]
    v_mfma_f32_16x16x32_bf16 v[72:75], v[112:115], v[156:159], v[72:75]
    buffer_load_dwordx4 v[112:115], v1, s[8:11], s45 offen sc1
    s_add_u32 s45, s45, 1024
    s_waitcnt vmcnt(16)
    v_mfma_f32_16x16x32_bf16 v[16:19], v[116:119], v[144:147], v[16:19]
    ds_read_b64_tr_b16 v[136:137], v162 offset:8192
    ds_read_b64_tr_b16 v[138:139], v162 offset:9216
    v_mfma_f32_16x16x32_bf16 v[36:39], v[116:119], v[148:151], v[36:39]
    s_add_u32 m0, s39, 6144
    s_add_u32 s25, s54, s43
    s_add_u32 s25, s25, 20480
    buffer_load_dwordx4 v1, s[8:11], s25 offen sc1 lds
    v_mfma_f32_16x16x32_bf16 v[56:59], v[116:119], v[152:155], v[56:59]
    v_mfma_f32_16x16x32_bf16 v[76:79], v[116:119], v[156:159], v[76:79]
    buffer_load_dwordx4 v[116:119], v1, s[8:11], s46 offen sc1
    s_add_u32 s46, s46, 1024
    s_waitcnt vmcnt(16)
    v_mfma_f32_16x16x32_bf16 v[20:23], v[120:123], v[144:147], v[20:23]
    ds_read_b64_tr_b16 v[140:141], v163 offset:8192
    ds_read_b64_tr_b16 v[142:143], v163 offset:9216
    v_mfma_f32_16x16x32_bf16 v[40:43], v[120:123], v[148:151], v[40:43]
    s_add_u32 m0, s39, 7168
    s_add_u32 s25, s54, s43
    s_add_u32 s25, s25, 40960
    buffer_load_dwordx4 v1, s[8:11], s25 offen sc1 lds
    v_mfma_f32_16x16x32_bf16 v[60:63], v[120:123], v[152:155], v[60:63]
    v_mfma_f32_16x16x32_bf16 v[80:83], v[120:123], v[156:159], v[80:83]
    buffer_load_dwordx4 v[120:123], v1, s[8:11], s47 offen sc1
    s_add_u32 s47, s47, 1024
    s_waitcnt vmcnt(17)
    v_mfma_f32_16x16x32_bf16 v[24:27], v[124:127], v[144:147], v[24:27]
    v_mfma_f32_16x16x32_bf16 v[44:47], v[124:127], v[148:151], v[44:47]
    v_mfma_f32_16x16x32_bf16 v[64:67], v[124:127], v[152:155], v[64:67]
    v_mfma_f32_16x16x32_bf16 v[84:87], v[124:127], v[156:159], v[84:87]
    buffer_load_dwordx4 v[124:127], v1, s[8:11], s48 offen sc1
    s_add_u32 s48, s48, 1024
    s_waitcnt lgkmcnt(0)
    s_waitcnt vmcnt(16)
    s_waitcnt vmcnt(20)
    v_mfma_f32_16x16x32_bf16 v[8:11], v[88:91], v[128:131], v[8:11]
    ds_read_b64_tr_b16 v[144:145], v160 offset:12288
    ds_read_b64_tr_b16 v[146:147], v160 offset:13312
    v_mfma_f32_16x16x32_bf16 v[28:31], v[88:91], v[132:135], v[28:31]
    s_add_u32 m0, s39, 8192
    s_add_u32 s25, s54, s43
    s_add_u32 s25, s25, 61440
    buffer_load_dwordx4 v1, s[8:11], s25 offen sc1 lds
    v_mfma_f32_16x16x32_bf16 v[48:51], v[88:91], v[136:139], v[48:51]
    v_mfma_f32_16x16x32_bf16 v[68:71], v[88:91], v[140:143], v[68:71]
    s_add_u32 s25, s54, s66
    s_add_u32 s25, s25, 20480
    buffer_load_dwordx4 v[88:91], v1, s[8:11], s25 offen sc1
    s_waitcnt vmcnt(16)
    v_mfma_f32_16x16x32_bf16 v[12:15], v[92:95], v[128:131], v[12:15]
    ds_read_b64_tr_b16 v[148:149], v161 offset:12288
    ds_read_b64_tr_b16 v[150:151], v161 offset:13312
    v_mfma_f32_16x16x32_bf16 v[32:35], v[92:95], v[132:135], v[32:35]
    s_add_u32 m0, s39, 9216
    s_add_u32 s25, s54, s43
    s_add_u32 s25, s25, 81920
    buffer_load_dwordx4 v1, s[8:11], s25 offen sc1 lds
    v_mfma_f32_16x16x32_bf16 v[52:55], v[92:95], v[136:139], v[52:55]
    v_mfma_f32_16x16x32_bf16 v[72:75], v[92:95], v[140:143], v[72:75]
    s_add_u32 s25, s54, s66
    s_add_u32 s25, s25, 40960
    buffer_load_dwordx4 v[92:95], v1, s[8:11], s25 offen sc1
    s_waitcnt vmcnt(16)
    v_mfma_f32_16x16x32_bf16 v[16:19], v[96:99], v[128:131], v[16:19]
    ds_read_b64_tr_b16 v[152:153], v162 offset:12288
    ds_read_b64_tr_b16 v[154:155], v162 offset:13312
    v_mfma_f32_16x16x32_bf16 v[36:39], v[96:99], v[132:135], v[36:39]
    s_add_u32 m0, s39, 10240
    s_add_u32 s25, s54, s49
    buffer_load_dwordx4 v1, s[8:11], s25 offen sc1 lds
    v_mfma_f32_16x16x32_bf16 v[56:59], v[96:99], v[136:139], v[56:59]
    v_mfma_f32_16x16x32_bf16 v[76:79], v[96:99], v[140:143], v[76:79]
    s_add_u32 s25, s54, s66
    s_add_u32 s25, s25, 61440
    buffer_load_dwordx4 v[96:99], v1, s[8:11], s25 offen sc1
    s_waitcnt vmcnt(16)
    v_mfma_f32_16x16x32_bf16 v[20:23], v[100:103], v[128:131], v[20:23]
    ds_read_b64_tr_b16 v[156:157], v163 offset:12288
    ds_read_b64_tr_b16 v[158:159], v163 offset:13312
    v_mfma_f32_16x16x32_bf16 v[40:43], v[100:103], v[132:135], v[40:43]
    s_add_u32 m0, s39, 11264
    s_add_u32 s25, s54, s49
    s_add_u32 s25, s25, 20480
    buffer_load_dwordx4 v1, s[8:11], s25 offen sc1 lds
    v_mfma_f32_16x16x32_bf16 v[60:63], v[100:103], v[136:139], v[60:63]
    v_mfma_f32_16x16x32_bf16 v[80:83], v[100:103], v[140:143], v[80:83]
    s_add_u32 s25, s54, s66
    s_add_u32 s25, s25, 81920
    buffer_load_dwordx4 v[100:103], v1, s[8:11], s25 offen sc1
    s_waitcnt vmcnt(17)
    v_mfma_f32_16x16x32_bf16 v[24:27], v[104:107], v[128:131], v[24:27]
    v_mfma_f32_16x16x32_bf16 v[44:47], v[104:107], v[132:135], v[44:47]
    v_mfma_f32_16x16x32_bf16 v[64:67], v[104:107], v[136:139], v[64:67]
    v_mfma_f32_16x16x32_bf16 v[84:87], v[104:107], v[140:143], v[84:87]
    s_add_u32 s25, s54, s69
    buffer_load_dwordx4 v[104:107], v1, s[8:11], s25 offen sc1
    s_waitcnt lgkmcnt(0)
    s_add_u32 m0, s39, 12288
    s_add_u32 s25, s54, s49
    s_add_u32 s25, s25, 40960
    buffer_load_dwordx4 v1, s[8:11], s25 offen sc1 lds
    s_add_u32 m0, s39, 13312
    s_add_u32 s25, s54, s49
    s_add_u32 s25, s25, 61440
    buffer_load_dwordx4 v1, s[8:11], s25 offen sc1 lds
    s_add_u32 m0, s39, 14336
    s_add_u32 s25, s54, s49
    s_add_u32 s25, s25, 81920
    buffer_load_dwordx4 v1, s[8:11], s25 offen sc1 lds
    s_add_u32 m0, s39, 15360
    s_add_u32 s25, s54, s66
    buffer_load_dwordx4 v1, s[8:11], s25 offen sc1 lds
    s_xor_b32 s25, s36, 0
    s_mul_i32 s25, s25, 20480
    s_add_u32 s50, s55, s25
    s_xor_b32 s25, s36, 1
    s_mul_i32 s25, s25, 20480
    s_add_u32 s51, s55, s25
    s_xor_b32 s25, s36, 2
    s_mul_i32 s25, s25, 20480
    s_add_u32 s52, s55, s25
    s_xor_b32 s25, s36, 3
    s_mul_i32 s25, s25, 20480
    s_add_u32 s53, s55, s25
    v_add_u32 v7, s39, v1
    v_and_b32 v2, 15, v0
    v_mul_u32_u24 v2, 1280, v2
    v_lshrrev_b32 v4, 4, v0
    v_lshl_add_u32 v2, v4, 3, v2
    s_mov_b32 s12, s4
    s_and_b32 s13, s5, 0xffff
    s_mov_b32 s14, 0x280000
    s_mov_b32 s15, 0x00020000
    s_mov_b32 s16, s70
    s_and_b32 s17, s71, 0xffff
    s_mov_b32 s18, 0x280000
    s_mov_b32 s19, 0x00020000
    s_lshr_b32 s25, s40, 2
    s_add_u32 s25, s25, 72
    s_lshl_b32 s25, s25, 8
    v_mov_b32 v4, s25
    s_mov_b32 s26, 0x1200000
m3_o_poll:
    buffer_load_dword v6, v4, s[8:11], s26 offen sc1
    s_waitcnt vmcnt(0)
    v_cmp_gt_u32 vcc, 32, v6
    s_nop 4
    s_cbranch_vccz m3_o_go
    s_sleep 1
    s_sub_u32 s68, s68, 1
    s_cbranch_scc0 m3_o_poll
    s_mov_b32 s68, 0
m3_o_go:
    s_add_u32 s25, s50, s42
    buffer_load_dwordx4 v[128:131], v1, s[8:11], s25 offen sc1
    s_add_u32 s25, s51, s42
    buffer_load_dwordx4 v[132:135], v1, s[8:11], s25 offen sc1
    s_add_u32 s25, s52, s42
    buffer_load_dwordx4 v[136:139], v1, s[8:11], s25 offen sc1
    s_add_u32 s25, s53, s42
    buffer_load_dwordx4 v[140:143], v1, s[8:11], s25 offen sc1
    s_waitcnt vmcnt(24)
    v_mfma_f32_16x16x32_bf16 v[8:11], v[108:111], v[144:147], v[8:11]
    v_mfma_f32_16x16x32_bf16 v[28:31], v[108:111], v[148:151], v[28:31]
    v_mfma_f32_16x16x32_bf16 v[48:51], v[108:111], v[152:155], v[48:51]
    v_mfma_f32_16x16x32_bf16 v[68:71], v[108:111], v[156:159], v[68:71]
    s_add_u32 s25, s54, s69
    s_add_u32 s25, s25, 20480
    buffer_load_dwordx4 v[108:111], v1, s[8:11], s25 offen sc1
    s_waitcnt vmcnt(23)
    v_mfma_f32_16x16x32_bf16 v[12:15], v[112:115], v[144:147], v[12:15]
    v_mfma_f32_16x16x32_bf16 v[32:35], v[112:115], v[148:151], v[32:35]
    v_mfma_f32_16x16x32_bf16 v[52:55], v[112:115], v[152:155], v[52:55]
    v_mfma_f32_16x16x32_bf16 v[72:75], v[112:115], v[156:159], v[72:75]
    s_add_u32 s25, s54, s69
    s_add_u32 s25, s25, 40960
    buffer_load_dwordx4 v[112:115], v1, s[8:11], s25 offen sc1
    s_waitcnt vmcnt(22)
    v_mfma_f32_16x16x32_bf16 v[16:19], v[116:119], v[144:147], v[16:19]
    v_mfma_f32_16x16x32_bf16 v[36:39], v[116:119], v[148:151], v[36:39]
    v_mfma_f32_16x16x32_bf16 v[56:59], v[116:119], v[152:155], v[56:59]
    v_mfma_f32_16x16x32_bf16 v[76:79], v[116:119], v[156:159], v[76:79]
    s_add_u32 s25, s54, s69
    s_add_u32 s25, s25, 61440
    buffer_load_dwordx4 v[116:119], v1, s[8:11], s25 offen sc1
    s_waitcnt vmcnt(21)
    v_mfma_f32_16x16x32_bf16 v[20:23], v[120:123], v[144:147], v[20:23]
    v_mfma_f32_16x16x32_bf16 v[40:43], v[120:123], v[148:151], v[40:43]
    v_mfma_f32_16x16x32_bf16 v[60:63], v[120:123], v[152:155], v[60:63]
    v_mfma_f32_16x16x32_bf16 v[80:83], v[120:123], v[156:159], v[80:83]
    s_add_u32 s25, s54, s69
    s_add_u32 s25, s25, 81920
    buffer_load_dwordx4 v[120:123], v1, s[8:11], s25 offen sc1
    s_waitcnt vmcnt(21)
    v_mfma_f32_16x16x32_bf16 v[24:27], v[124:127], v[144:147], v[24:27]
    v_mfma_f32_16x16x32_bf16 v[44:47], v[124:127], v[148:151], v[44:47]
    v_mfma_f32_16x16x32_bf16 v[64:67], v[124:127], v[152:155], v[64:67]
    v_mfma_f32_16x16x32_bf16 v[84:87], v[124:127], v[156:159], v[84:87]
    s_setprio 1
    s_add_u32 s25, s50, s43
    buffer_load_dwordx4 v[144:147], v1, s[8:11], s25 offen sc1
    s_add_u32 s25, s51, s43
    buffer_load_dwordx4 v[148:151], v1, s[8:11], s25 offen sc1
    s_add_u32 s25, s52, s43
    buffer_load_dwordx4 v[152:155], v1, s[8:11], s25 offen sc1
    s_add_u32 s25, s53, s43
    buffer_load_dwordx4 v[156:159], v1, s[8:11], s25 offen sc1
    ds_read_b128 v[160:163], v7 offset:1024
    ds_read_b128 v[124:127], v7
    s_waitcnt vmcnt(8)
    ds_read_b128 v[164:167], v7 offset:2048
    s_waitcnt lgkmcnt(1)
    v_mfma_f32_16x16x32_bf16 v[8:11], v[124:127], v[128:131], v[8:11]
    v_mfma_f32_16x16x32_bf16 v[28:31], v[124:127], v[132:135], v[28:31]
    v_mfma_f32_16x16x32_bf16 v[48:51], v[124:127], v[136:139], v[48:51]
    v_mfma_f32_16x16x32_bf16 v[68:71], v[124:127], v[140:143], v[68:71]
    ds_read_b128 v[124:127], v7 offset:3072
    s_waitcnt lgkmcnt(2)
    v_mfma_f32_16x16x32_bf16 v[12:15], v[160:163], v[128:131], v[12:15]
    v_mfma_f32_16x16x32_bf16 v[32:35], v[160:163], v[132:135], v[32:35]
    v_mfma_f32_16x16x32_bf16 v[52:55], v[160:163], v[136:139], v[52:55]
    v_mfma_f32_16x16x32_bf16 v[72:75], v[160:163], v[140:143], v[72:75]
    ds_read_b128 v[160:163], v7 offset:4096
    s_waitcnt lgkmcnt(2)
    v_mfma_f32_16x16x32_bf16 v[16:19], v[164:167], v[128:131], v[16:19]
    v_mfma_f32_16x16x32_bf16 v[36:39], v[164:167], v[132:135], v[36:39]
    v_mfma_f32_16x16x32_bf16 v[56:59], v[164:167], v[136:139], v[56:59]
    v_mfma_f32_16x16x32_bf16 v[76:79], v[164:167], v[140:143], v[76:79]
    ds_read_b128 v[164:167], v7 offset:5120
    s_waitcnt lgkmcnt(2)
    v_mfma_f32_16x16x32_bf16 v[20:23], v[124:127], v[128:131], v[20:23]
    v_mfma_f32_16x16x32_bf16 v[40:43], v[124:127], v[132:135], v[40:43]
    v_mfma_f32_16x16x32_bf16 v[60:63], v[124:127], v[136:139], v[60:63]
    v_mfma_f32_16x16x32_bf16 v[80:83], v[124:127], v[140:143], v[80:83]
    ds_read_b128 v[124:127], v7 offset:6144
    s_waitcnt lgkmcnt(2)
    v_mfma_f32_16x16x32_bf16 v[24:27], v[160:163], v[128:131], v[24:27]
    v_mfma_f32_16x16x32_bf16 v[44:47], v[160:163], v[132:135], v[44:47]
    v_mfma_f32_16x16x32_bf16 v[64:67], v[160:163], v[136:139], v[64:67]
    v_mfma_f32_16x16x32_bf16 v[84:87], v[160:163], v[140:143], v[84:87]
    s_add_u32 s25, s50, s49
    buffer_load_dwordx4 v[128:131], v1, s[8:11], s25 offen sc1
    s_add_u32 s25, s51, s49
    buffer_load_dwordx4 v[132:135], v1, s[8:11], s25 offen sc1
    s_add_u32 s25, s52, s49
    buffer_load_dwordx4 v[136:139], v1, s[8:11], s25 offen sc1
    s_add_u32 s25, s53, s49
    buffer_load_dwordx4 v[140:143], v1, s[8:11], s25 offen sc1
    s_waitcnt vmcnt(4)
    ds_read_b128 v[160:163], v7 offset:7168
    s_waitcnt lgkmcnt(2)
    v_mfma_f32_16x16x32_bf16 v[8:11], v[164:167], v[144:147], v[8:11]
    v_mfma_f32_16x16x32_bf16 v[28:31], v[164:167], v[148:151], v[28:31]
    v_mfma_f32_16x16x32_bf16 v[48:51], v[164:167], v[152:155], v[48:51]
    v_mfma_f32_16x16x32_bf16 v[68:71], v[164:167], v[156:159], v[68:71]
    ds_read_b128 v[164:167], v7 offset:8192
    s_waitcnt lgkmcnt(2)
    v_mfma_f32_16x16x32_bf16 v[12:15], v[124:127], v[144:147], v[12:15]
    v_mfma_f32_16x16x32_bf16 v[32:35], v[124:127], v[148:151], v[32:35]
    v_mfma_f32_16x16x32_bf16 v[52:55], v[124:127], v[152:155], v[52:55]
    v_mfma_f32_16x16x32_bf16 v[72:75], v[124:127], v[156:159], v[72:75]
    ds_read_b128 v[124:127], v7 offset:9216
    s_waitcnt lgkmcnt(2)
    v_mfma_f32_16x16x32_bf16 v[16:19], v[160:163], v[144:147], v[16:19]
    v_mfma_f32_16x16x32_bf16 v[36:39], v[160:163], v[148:151], v[36:39]
    v_mfma_f32_16x16x32_bf16 v[56:59], v[160:163], v[152:155], v[56:59]
    v_mfma_f32_16x16x32_bf16 v[76:79], v[160:163], v[156:159], v[76:79]
    ds_read_b128 v[160:163], v7 offset:10240
    s_waitcnt lgkmcnt(2)
    v_mfma_f32_16x16x32_bf16 v[20:23], v[164:167], v[144:147], v[20:23]
    v_mfma_f32_16x16x32_bf16 v[40:43], v[164:167], v[148:151], v[40:43]
    v_mfma_f32_16x16x32_bf16 v[60:63], v[164:167], v[152:155], v[60:63]
    v_mfma_f32_16x16x32_bf16 v[80:83], v[164:167], v[156:159], v[80:83]
    ds_read_b128 v[164:167], v7 offset:11264
    s_waitcnt lgkmcnt(2)
    v_mfma_f32_16x16x32_bf16 v[24:27], v[124:127], v[144:147], v[24:27]
    v_mfma_f32_16x16x32_bf16 v[44:47], v[124:127], v[148:151], v[44:47]
    v_mfma_f32_16x16x32_bf16 v[64:67], v[124:127], v[152:155], v[64:67]
    v_mfma_f32_16x16x32_bf16 v[84:87], v[124:127], v[156:159], v[84:87]
    s_add_u32 s25, s50, s66
    buffer_load_dwordx4 v[144:147], v1, s[8:11], s25 offen sc1
    s_add_u32 s25, s51, s66
    buffer_load_dwordx4 v[148:151], v1, s[8:11], s25 offen sc1
    s_add_u32 s25, s52, s66
    buffer_load_dwordx4 v[152:155], v1, s[8:11], s25 offen sc1
    s_add_u32 s25, s53, s66
    buffer_load_dwordx4 v[156:159], v1, s[8:11], s25 offen sc1
    s_waitcnt vmcnt(4)
    ds_read_b128 v[124:127], v7 offset:12288
    s_waitcnt lgkmcnt(2)
    v_mfma_f32_16x16x32_bf16 v[8:11], v[160:163], v[128:131], v[8:11]
    v_mfma_f32_16x16x32_bf16 v[28:31], v[160:163], v[132:135], v[28:31]
    v_mfma_f32_16x16x32_bf16 v[48:51], v[160:163], v[136:139], v[48:51]
    v_mfma_f32_16x16x32_bf16 v[68:71], v[160:163], v[140:143], v[68:71]
    ds_read_b128 v[160:163], v7 offset:13312
    s_waitcnt lgkmcnt(2)
    v_mfma_f32_16x16x32_bf16 v[12:15], v[164:167], v[128:131], v[12:15]
    v_mfma_f32_16x16x32_bf16 v[32:35], v[164:167], v[132:135], v[32:35]
    v_mfma_f32_16x16x32_bf16 v[52:55], v[164:167], v[136:139], v[52:55]
    v_mfma_f32_16x16x32_bf16 v[72:75], v[164:167], v[140:143], v[72:75]
    ds_read_b128 v[164:167], v7 offset:14336
    s_waitcnt lgkmcnt(2)
    v_mfma_f32_16x16x32_bf16 v[16:19], v[124:127], v[128:131], v[16:19]
    v_mfma_f32_16x16x32_bf16 v[36:39], v[124:127], v[132:135], v[36:39]
    v_mfma_f32_16x16x32_bf16 v[56:59], v[124:127], v[136:139], v[56:59]
    v_mfma_f32_16x16x32_bf16 v[76:79], v[124:127], v[140:143], v[76:79]
    ds_read_b128 v[124:127], v7 offset:15360
    s_waitcnt lgkmcnt(2)
    v_mfma_f32_16x16x32_bf16 v[20:23], v[160:163], v[128:131], v[20:23]
    v_mfma_f32_16x16x32_bf16 v[40:43], v[160:163], v[132:135], v[40:43]
    v_mfma_f32_16x16x32_bf16 v[60:63], v[160:163], v[136:139], v[60:63]
    v_mfma_f32_16x16x32_bf16 v[80:83], v[160:163], v[140:143], v[80:83]
    s_waitcnt lgkmcnt(1)
    v_mfma_f32_16x16x32_bf16 v[24:27], v[164:167], v[128:131], v[24:27]
    v_mfma_f32_16x16x32_bf16 v[44:47], v[164:167], v[132:135], v[44:47]
    v_mfma_f32_16x16x32_bf16 v[64:67], v[164:167], v[136:139], v[64:67]
    v_mfma_f32_16x16x32_bf16 v[84:87], v[164:167], v[140:143], v[84:87]
    s_add_u32 s25, s50, s69
    buffer_load_dwordx4 v[128:131], v1, s[8:11], s25 offen sc1
    s_add_u32 s25, s51, s69
    buffer_load_dwordx4 v[132:135], v1, s[8:11], s25 offen sc1
    s_add_u32 s25, s52, s69
    buffer_load_dwordx4 v[136:139], v1, s[8:11], s25 offen sc1
    s_add_u32 s25, s53, s69
    buffer_load_dwordx4 v[140:143], v1, s[8:11], s25 offen sc1
    s_waitcnt vmcnt(4)
    s_waitcnt lgkmcnt(0)
    v_mfma_f32_16x16x32_bf16 v[8:11], v[124:127], v[144:147], v[8:11]
    v_mfma_f32_16x16x32_bf16 v[28:31], v[124:127], v[148:151], v[28:31]
    v_mfma_f32_16x16x32_bf16 v[48:51], v[124:127], v[152:155], v[48:51]
    v_mfma_f32_16x16x32_bf16 v[68:71], v[124:127], v[156:159], v[68:71]
    s_waitcnt vmcnt(35)
    v_mfma_f32_16x16x32_bf16 v[12:15], v[88:91], v[144:147], v[12:15]
    v_mfma_f32_16x16x32_bf16 v[32:35], v[88:91], v[148:151], v[32:35]
    v_mfma_f32_16x16x32_bf16 v[52:55], v[88:91], v[152:155], v[52:55]
    v_mfma_f32_16x16x32_bf16 v[72:75], v[88:91], v[156:159], v[72:75]
    s_waitcnt vmcnt(33)
    v_mfma_f32_16x16x32_bf16 v[16:19], v[92:95], v[144:147], v[16:19]
    v_mfma_f32_16x16x32_bf16 v[36:39], v[92:95], v[148:151], v[36:39]
    v_mfma_f32_16x16x32_bf16 v[56:59], v[92:95], v[152:155], v[56:59]
    v_mfma_f32_16x16x32_bf16 v[76:79], v[92:95], v[156:159], v[76:79]
    s_waitcnt vmcnt(31)
    v_mfma_f32_16x16x32_bf16 v[20:23], v[96:99], v[144:147], v[20:23]
    v_mfma_f32_16x16x32_bf16 v[40:43], v[96:99], v[148:151], v[40:43]
    v_mfma_f32_16x16x32_bf16 v[60:63], v[96:99], v[152:155], v[60:63]
    v_mfma_f32_16x16x32_bf16 v[80:83], v[96:99], v[156:159], v[80:83]
    s_waitcnt vmcnt(29)
    v_mfma_f32_16x16x32_bf16 v[24:27], v[100:103], v[144:147], v[24:27]
    v_mfma_f32_16x16x32_bf16 v[44:47], v[100:103], v[148:151], v[44:47]
    v_mfma_f32_16x16x32_bf16 v[64:67], v[100:103], v[152:155], v[64:67]
    v_mfma_f32_16x16x32_bf16 v[84:87], v[100:103], v[156:159], v[84:87]
    buffer_load_dwordx2 v[144:145], v2, s[12:15], s37 offen offset:0
    buffer_load_dwordx2 v[146:147], v2, s[12:15], s37 offen offset:32
    buffer_load_dwordx2 v[148:149], v2, s[12:15], s37 offen offset:64
    buffer_load_dwordx2 v[150:151], v2, s[12:15], s37 offen offset:96
    buffer_load_dwordx2 v[152:153], v2, s[12:15], s37 offen offset:128
    s_waitcnt vmcnt(5)
    s_waitcnt vmcnt(33)
    v_mfma_f32_16x16x32_bf16 v[8:11], v[104:107], v[128:131], v[8:11]
    v_mfma_f32_16x16x32_bf16 v[28:31], v[104:107], v[132:135], v[28:31]
    v_mfma_f32_16x16x32_bf16 v[48:51], v[104:107], v[136:139], v[48:51]
    v_mfma_f32_16x16x32_bf16 v[68:71], v[104:107], v[140:143], v[68:71]
    s_waitcnt vmcnt(24)
    v_mfma_f32_16x16x32_bf16 v[12:15], v[108:111], v[128:131], v[12:15]
    v_mfma_f32_16x16x32_bf16 v[32:35], v[108:111], v[132:135], v[32:35]
    v_mfma_f32_16x16x32_bf16 v[52:55], v[108:111], v[136:139], v[52:55]
    v_mfma_f32_16x16x32_bf16 v[72:75], v[108:111], v[140:143], v[72:75]
    s_waitcnt vmcnt(23)
    v_mfma_f32_16x16x32_bf16 v[16:19], v[112:115], v[128:131], v[16:19]
    ds_write_b128 v7, v[28:31] offset:0
    v_mfma_f32_16x16x32_bf16 v[36:39], v[112:115], v[132:135], v[36:39]
    ds_write_b128 v7, v[48:51] offset:5120
    v_mfma_f32_16x16x32_bf16 v[56:59], v[112:115], v[136:139], v[56:59]
    ds_write_b128 v7, v[68:71] offset:10240
    v_mfma_f32_16x16x32_bf16 v[76:79], v[112:115], v[140:143], v[76:79]
    s_waitcnt vmcnt(22)
    v_mfma_f32_16x16x32_bf16 v[20:23], v[116:119], v[128:131], v[20:23]
    ds_write_b128 v7, v[32:35] offset:1024
    v_mfma_f32_16x16x32_bf16 v[40:43], v[116:119], v[132:135], v[40:43]
    ds_write_b128 v7, v[52:55] offset:6144
    v_mfma_f32_16x16x32_bf16 v[60:63], v[116:119], v[136:139], v[60:63]
    ds_write_b128 v7, v[72:75] offset:11264
    v_mfma_f32_16x16x32_bf16 v[80:83], v[116:119], v[140:143], v[80:83]
    s_waitcnt vmcnt(21)
    v_mfma_f32_16x16x32_bf16 v[24:27], v[120:123], v[128:131], v[24:27]
    ds_write_b128 v7, v[36:39] offset:2048
    v_mfma_f32_16x16x32_bf16 v[44:47], v[120:123], v[132:135], v[44:47]
    ds_write_b128 v7, v[56:59] offset:7168
    v_mfma_f32_16x16x32_bf16 v[64:67], v[120:123], v[136:139], v[64:67]
    ds_write_b128 v7, v[76:79] offset:12288
    v_mfma_f32_16x16x32_bf16 v[84:87], v[120:123], v[140:143], v[84:87]
    v_lshlrev_b32 v4, 16, v3
    s_nop 1
    ds_write_b128 v7, v[40:43] offset:3072
    ds_write_b128 v7, v[60:63] offset:8192
    ds_write_b128 v7, v[80:83] offset:13312
    s_nop 1
    ds_write_b128 v7, v[44:47] offset:4096
    ds_write_b128 v7, v[64:67] offset:9216
    ds_write_b128 v7, v[84:87] offset:14336
    s_waitcnt lgkmcnt(0)
    v_mov_b32 v5, 151552
    v_mov_b32 v6, 1
    s_mov_b64 exec, 1
    ds_add_u32 v5, v6 offset:16
    s_mov_b64 exec, -1
    s_waitcnt vmcnt(0)
    v_lshlrev_b32 v88, 16, v144
    v_and_b32 v89, 0xffff0000, v144
    v_lshlrev_b32 v90, 16, v145
    v_and_b32 v91, 0xffff0000, v145
    v_lshlrev_b32 v92, 16, v146
    v_and_b32 v93, 0xffff0000, v146
    v_lshlrev_b32 v94, 16, v147
    v_and_b32 v95, 0xffff0000, v147
    v_lshlrev_b32 v96, 16, v148
    v_and_b32 v97, 0xffff0000, v148
    v_lshlrev_b32 v98, 16, v149
    v_and_b32 v99, 0xffff0000, v149
    v_lshlrev_b32 v100, 16, v150
    v_and_b32 v101, 0xffff0000, v150
    v_lshlrev_b32 v102, 16, v151
    v_and_b32 v103, 0xffff0000, v151
    v_lshlrev_b32 v104, 16, v152
    v_and_b32 v105, 0xffff0000, v152
    v_lshlrev_b32 v106, 16, v153
    v_and_b32 v107, 0xffff0000, v153
    v_add_f32 v8, v8, v4
    v_add_f32 v9, v9, v4
    v_add_f32 v10, v10, v4
    v_add_f32 v11, v11, v4
    v_add_f32 v12, v12, v4
    v_add_f32 v13, v13, v4
    v_add_f32 v14, v14, v4
    v_add_f32 v15, v15, v4
    v_add_f32 v16, v16, v4
    v_add_f32 v17, v17, v4
    v_add_f32 v18, v18, v4
    v_add_f32 v19, v19, v4
    v_add_f32 v20, v20, v4
    v_add_f32 v21, v21, v4
    v_add_f32 v22, v22, v4
    v_add_f32 v23, v23, v4
    v_add_f32 v24, v24, v4
    v_add_f32 v25, v25, v4
    v_add_f32 v26, v26, v4
    v_add_f32 v27, v27, v4
    v_add_f32 v8, v8, v88
    v_add_f32 v9, v9, v89
    v_add_f32 v10, v10, v90
    v_add_f32 v11, v11, v91
    v_add_f32 v12, v12, v92
    v_add_f32 v13, v13, v93
    v_add_f32 v14, v14, v94
    v_add_f32 v15, v15, v95
    v_add_f32 v16, v16, v96
    v_add_f32 v17, v17, v97
    v_add_f32 v18, v18, v98
    v_add_f32 v19, v19, v99
    v_add_f32 v20, v20, v100
    v_add_f32 v21, v21, v101
    v_add_f32 v22, v22, v102
    v_add_f32 v23, v23, v103
    v_add_f32 v24, v24, v104
    v_add_f32 v25, v25, v105
    v_add_f32 v26, v26, v106
    v_add_f32 v27, v27, v107
    s_add_u32 s29, s29, 4
    v_mov_b32 v5, 151552
m3_sg_spin:
    ds_read_b32 v6, v5 offset:16
    s_waitcnt lgkmcnt(0)
    v_readfirstlane_b32 s25, v6
    s_cmp_ge_u32 s25, s29
    s_cbranch_scc1 m3_sg_done
    s_sleep 0
    s_sub_u32 s68, s68, 1
    s_cbranch_scc0 m3_sg_spin
    s_mov_b32 s68, 0
m3_sg_done:
    s_xor_b32 s25, s36, 1
    s_lshl_b32 s25, s25, 14
    v_add_u32 v7, s25, v1
    ds_read_b128 v[28:31], v7 offset:0
    ds_read_b128 v[32:35], v7 offset:1024
    ds_read_b128 v[36:39], v7 offset:2048
    ds_read_b128 v[40:43], v7 offset:3072
    ds_read_b128 v[44:47], v7 offset:4096
    s_xor_b32 s25, s36, 2
    s_lshl_b32 s25, s25, 14
    v_add_u32 v7, s25, v1
    ds_read_b128 v[48:51], v7 offset:5120
    ds_read_b128 v[52:55], v7 offset:6144
    ds_read_b128 v[56:59], v7 offset:7168
    ds_read_b128 v[60:63], v7 offset:8192
    ds_read_b128 v[64:67], v7 offset:9216
    s_xor_b32 s25, s36, 3
    s_lshl_b32 s25, s25, 14
    v_add_u32 v7, s25, v1
    ds_read_b128 v[68:71], v7 offset:10240
    ds_read_b128 v[72:75], v7 offset:11264
    ds_read_b128 v[76:79], v7 offset:12288
    ds_read_b128 v[80:83], v7 offset:13312
    ds_read_b128 v[84:87], v7 offset:14336
    s_waitcnt lgkmcnt(10)
    v_add_f32 v8, v8, v28
    v_add_f32 v9, v9, v29
    v_add_f32 v10, v10, v30
    v_add_f32 v11, v11, v31
    v_add_f32 v12, v12, v32
    v_add_f32 v13, v13, v33
    v_add_f32 v14, v14, v34
    v_add_f32 v15, v15, v35
    v_add_f32 v16, v16, v36
    v_add_f32 v17, v17, v37
    v_add_f32 v18, v18, v38
    v_add_f32 v19, v19, v39
    v_add_f32 v20, v20, v40
    v_add_f32 v21, v21, v41
    v_add_f32 v22, v22, v42
    v_add_f32 v23, v23, v43
    v_add_f32 v24, v24, v44
    v_add_f32 v25, v25, v45
    v_add_f32 v26, v26, v46
    v_add_f32 v27, v27, v47
    s_waitcnt lgkmcnt(5)
    v_add_f32 v8, v8, v48
    v_add_f32 v9, v9, v49
    v_add_f32 v10, v10, v50
    v_add_f32 v11, v11, v51
    v_add_f32 v12, v12, v52
    v_add_f32 v13, v13, v53
    v_add_f32 v14, v14, v54
    v_add_f32 v15, v15, v55
    v_add_f32 v16, v16, v56
    v_add_f32 v17, v17, v57
    v_add_f32 v18, v18, v58
    v_add_f32 v19, v19, v59
    v_add_f32 v20, v20, v60
    v_add_f32 v21, v21, v61
    v_add_f32 v22, v22, v62
    v_add_f32 v23, v23, v63
    v_add_f32 v24, v24, v64
    v_add_f32 v25, v25, v65
    v_add_f32 v26, v26, v66
    v_add_f32 v27, v27, v67
    s_waitcnt lgkmcnt(0)
    v_add_f32 v8, v8, v68
    v_add_f32 v9, v9, v69
    v_add_f32 v10, v10, v70
    v_add_f32 v11, v11, v71
    v_add_f32 v12, v12, v72
    v_add_f32 v13, v13, v73
    v_add_f32 v14, v14, v74
    v_add_f32 v15, v15, v75
    v_add_f32 v16, v16, v76
    v_add_f32 v17, v17, v77
    v_add_f32 v18, v18, v78
    v_add_f32 v19, v19, v79
    v_add_f32 v20, v20, v80
    v_add_f32 v21, v21, v81
    v_add_f32 v22, v22, v82
    v_add_f32 v23, v23, v83
    v_add_f32 v24, v24, v84
    v_add_f32 v25, v25, v85
    v_add_f32 v26, v26, v86
    v_add_f32 v27, v27, v87
    v_cvt_pk_bf16_f32 v8, v8, v9
    v_cvt_pk_bf16_f32 v9, v10, v11
    buffer_store_dwordx2 v[8:9], v2, s[16:19], s37 offen offset:0 nt
    v_cvt_pk_bf16_f32 v12, v12, v13
    v_cvt_pk_bf16_f32 v13, v14, v15
    buffer_store_dwordx2 v[12:13], v2, s[16:19], s37 offen offset:32 nt
    v_cvt_pk_bf16_f32 v16, v16, v17
    v_cvt_pk_bf16_f32 v17, v18, v19
    buffer_store_dwordx2 v[16:17], v2, s[16:19], s37 offen offset:64 nt
    v_cvt_pk_bf16_f32 v20, v20, v21
    v_cvt_pk_bf16_f32 v21, v22, v23
    buffer_store_dwordx2 v[20:21], v2, s[16:19], s37 offen offset:96 nt
    v_cvt_pk_bf16_f32 v24, v24, v25
    v_cvt_pk_bf16_f32 v25, v26, v27
    buffer_store_dwordx2 v[24:25], v2, s[16:19], s37 offen offset:128 nt
k_fin:
k_end:
    s_endpgm
p1_mma:
    s_waitcnt lgkmcnt(0)
    s_cmp_lg_u32 s22, 0
    s_cbranch_scc1 p1_nocpf
    s_getpc_b64 s[34:35]
p1_pc:
    s_sub_u32 s34, s34, p1_pc-parallel_sum__mha_block__mixer_token_mlp__prompt_kernel
    s_subb_u32 s35, s35, 0
    v_and_b32 v3, 15, v0
    s_lshl_b32 s25, s24, 10
    v_lshl_add_u32 v3, v3, 6, s25
    v_min_u32 v3, k_last-parallel_sum__mha_block__mixer_token_mlp__prompt_kernel, v3
    global_load_dword v167, v3, s[34:35]
p1_nocpf:
    s_mov_b32 s36, s22
    s_lshr_b32 s37, s36, 1
    s_and_b32 s38, s36, 1
    s_lshl_b32 s25, s37, 13
    v_and_b32 v1, 31, v0
    v_lshrrev_b32 v2, 5, v0
    v_bfe_u32 v3, v0, 1, 3
    v_xor_b32 v3, v3, v2
    v_lshlrev_b32 v3, 4, v3
    v_lshl_add_u32 v3, v1, 7, v3
    v_add_u32 v10, s25, v3
    v_xor_b32 v11, 0x20, v10
    v_xor_b32 v12, 0x40, v10
    v_xor_b32 v13, 0x60, v10
    v_mov_b32 v14, v10
    v_mov_b32 v15, v11
    v_mov_b32 v16, v12
    v_mov_b32 v17, v13
    v_bfe_u32 v3, v0, 2, 2
    v_lshlrev_b32 v3, 6, v3
    v_lshl_add_u32 v3, v2, 11, v3
    v_bfe_u32 v4, v0, 4, 1
    v_lshl_add_u32 v3, v4, 5, v3
    v_and_b32 v5, 3, v0
    v_lshl_add_u32 v3, v5, 3, v3
    s_lshl_b32 s25, s38, 9
    s_add_u32 s25, s25, 0x4000
    v_add_u32 v18, s25, v3
    v_add_u32 v19, 0x100, v18
    v_mov_b32 v20, v18
    v_mov_b32 v21, v19
    v_mov_b32 v22, 151552
    v_mov_b32 v23, 1
    v_mov_b32 v32, 0
    v_mov_b32 v33, 0
    v_mov_b32 v34, 0
    v_mov_b32 v35, 0
    s_lshl_b32 s41, s38, 8
    s_add_u32 s41, s41, 152064
    s_mov_b32 s40, 0
    s_mov_b32 s39, 9
    v_mfma_f32_32x32x16_bf16 v[96:111], v[32:35], v[32:35], 0
    v_mfma_f32_32x32x16_bf16 v[112:127], v[32:35], v[32:35], 0
    v_mfma_f32_32x32x16_bf16 v[128:143], v[32:35], v[32:35], 0
    v_mfma_f32_32x32x16_bf16 v[144:159], v[32:35], v[32:35], 0
    s_waitcnt lgkmcnt(0)
    s_mov_b32 s8, s20
    s_and_b32 s9, s21, 0xffff
    s_mov_b32 s10, 0x1300000
    s_mov_b32 s11, 0x00020000
    s_cmp_eq_u32 s75, 15
    s_cbranch_scc1 p1_spare
    s_lshl_b32 s43, s74, 1
    s_add_u32 s43, s43, s37
    s_cmp_ge_u32 s75, 10
    s_cbranch_scc1 p1_v
    v_and_b32 v3, 0x13, v1
    v_bfe_u32 v4, v1, 2, 1
    v_lshl_or_b32 v3, v4, 3, v3
    v_bfe_u32 v4, v1, 3, 1
    v_lshl_or_b32 v3, v4, 2, v3
    s_cmp_lt_u32 s75, 5
    s_cselect_b32 s44, 0x0, 0x280000
    s_cselect_b32 s25, 0, 5
    s_cselect_b32 s45, 0, 1
    s_cselect_b64 s[34:35], -1, 0
    v_cndmask_b32 v3, v3, v1, s[34:35]
    v_lshlrev_b32 v3, 4, v3
    s_mul_i32 s26, s43, 2560
    s_lshl_b32 s26, s26, s45
    s_add_u32 s44, s44, s26
    s_lshl_b32 s45, 81920, s45
    v_lshl_add_u32 v25, v2, 10, v3
    v_mad_u32_u24 v26, v2, s45, v3
    v_add_u32 v26, 2048, v26
    s_sub_u32 s25, s75, s25
    s_lshl_b32 s25, s25, 4
    s_lshl_b32 s26, s38, 3
    s_add_u32 s46, s25, s26
    s_mov_b32 s69, 0
    s_add_u32 s25, s46, 0
    s_mul_i32 s26, s25, 205
    s_lshr_b32 s26, s26, 10
    s_mul_i32 s27, s26, 5
    s_sub_u32 s25, s25, s27
    s_lshl_b32 s26, s26, 1
    s_cmp_ge_u32 s25, 3
    s_addc_u32 s26, s26, 0
    s_mul_i32 s26, s26, s45
    s_add_u32 s26, s26, s44
    s_lshl_b32 s27, 0x200, s25
    s_and_b32 s27, s27, 0x2400
    s_cselect_b32 s27, 0x200, 0
    s_add_u32 s50, s26, s27
    s_cmp_eq_u32 s25, 2
    s_cselect_b32 s27, 1, 0
    s_or_b32 s69, s69, s27
    s_add_u32 s25, s46, 1
    s_mul_i32 s26, s25, 205
    s_lshr_b32 s26, s26, 10
    s_mul_i32 s27, s26, 5
    s_sub_u32 s25, s25, s27
    s_lshl_b32 s26, s26, 1
    s_cmp_ge_u32 s25, 3
    s_addc_u32 s26, s26, 0
    s_mul_i32 s26, s26, s45
    s_add_u32 s26, s26, s44
    s_lshl_b32 s27, 0x200, s25
    s_and_b32 s27, s27, 0x2400
    s_cselect_b32 s27, 0x200, 0
    s_add_u32 s51, s26, s27
    s_cmp_eq_u32 s25, 2
    s_cselect_b32 s27, 2, 0
    s_or_b32 s69, s69, s27
    s_add_u32 s25, s46, 2
    s_mul_i32 s26, s25, 205
    s_lshr_b32 s26, s26, 10
    s_mul_i32 s27, s26, 5
    s_sub_u32 s25, s25, s27
    s_lshl_b32 s26, s26, 1
    s_cmp_ge_u32 s25, 3
    s_addc_u32 s26, s26, 0
    s_mul_i32 s26, s26, s45
    s_add_u32 s26, s26, s44
    s_lshl_b32 s27, 0x200, s25
    s_and_b32 s27, s27, 0x2400
    s_cselect_b32 s27, 0x200, 0
    s_add_u32 s52, s26, s27
    s_cmp_eq_u32 s25, 2
    s_cselect_b32 s27, 4, 0
    s_or_b32 s69, s69, s27
    s_add_u32 s25, s46, 3
    s_mul_i32 s26, s25, 205
    s_lshr_b32 s26, s26, 10
    s_mul_i32 s27, s26, 5
    s_sub_u32 s25, s25, s27
    s_lshl_b32 s26, s26, 1
    s_cmp_ge_u32 s25, 3
    s_addc_u32 s26, s26, 0
    s_mul_i32 s26, s26, s45
    s_add_u32 s26, s26, s44
    s_lshl_b32 s27, 0x200, s25
    s_and_b32 s27, s27, 0x2400
    s_cselect_b32 s27, 0x200, 0
    s_add_u32 s53, s26, s27
    s_cmp_eq_u32 s25, 2
    s_cselect_b32 s27, 8, 0
    s_or_b32 s69, s69, s27
    s_add_u32 s25, s46, 4
    s_mul_i32 s26, s25, 205
    s_lshr_b32 s26, s26, 10
    s_mul_i32 s27, s26, 5
    s_sub_u32 s25, s25, s27
    s_lshl_b32 s26, s26, 1
    s_cmp_ge_u32 s25, 3
    s_addc_u32 s26, s26, 0
    s_mul_i32 s26, s26, s45
    s_add_u32 s26, s26, s44
    s_lshl_b32 s27, 0x200, s25
    s_and_b32 s27, s27, 0x2400
    s_cselect_b32 s27, 0x200, 0
    s_add_u32 s54, s26, s27
    s_cmp_eq_u32 s25, 2
    s_cselect_b32 s27, 16, 0
    s_or_b32 s69, s69, s27
    s_add_u32 s25, s46, 5
    s_mul_i32 s26, s25, 205
    s_lshr_b32 s26, s26, 10
    s_mul_i32 s27, s26, 5
    s_sub_u32 s25, s25, s27
    s_lshl_b32 s26, s26, 1
    s_cmp_ge_u32 s25, 3
    s_addc_u32 s26, s26, 0
    s_mul_i32 s26, s26, s45
    s_add_u32 s26, s26, s44
    s_lshl_b32 s27, 0x200, s25
    s_and_b32 s27, s27, 0x2400
    s_cselect_b32 s27, 0x200, 0
    s_add_u32 s55, s26, s27
    s_cmp_eq_u32 s25, 2
    s_cselect_b32 s27, 32, 0
    s_or_b32 s69, s69, s27
    s_add_u32 s25, s46, 6
    s_mul_i32 s26, s25, 205
    s_lshr_b32 s26, s26, 10
    s_mul_i32 s27, s26, 5
    s_sub_u32 s25, s25, s27
    s_lshl_b32 s26, s26, 1
    s_cmp_ge_u32 s25, 3
    s_addc_u32 s26, s26, 0
    s_mul_i32 s26, s26, s45
    s_add_u32 s26, s26, s44
    s_lshl_b32 s27, 0x200, s25
    s_and_b32 s27, s27, 0x2400
    s_cselect_b32 s27, 0x200, 0
    s_add_u32 s66, s26, s27
    s_cmp_eq_u32 s25, 2
    s_cselect_b32 s27, 64, 0
    s_or_b32 s69, s69, s27
    s_add_u32 s25, s46, 7
    s_mul_i32 s26, s25, 205
    s_lshr_b32 s26, s26, 10
    s_mul_i32 s27, s26, 5
    s_sub_u32 s25, s25, s27
    s_lshl_b32 s26, s26, 1
    s_cmp_ge_u32 s25, 3
    s_addc_u32 s26, s26, 0
    s_mul_i32 s26, s26, s45
    s_add_u32 s26, s26, s44
    s_lshl_b32 s27, 0x200, s25
    s_and_b32 s27, s27, 0x2400
    s_cselect_b32 s27, 0x200, 0
    s_add_u32 s67, s26, s27
    s_cmp_eq_u32 s25, 2
    s_cselect_b32 s27, 128, 0
    s_or_b32 s69, s69, s27
    s_barrier
    ds_read_b64_tr_b16 v[40:41], v20 offset:0
    ds_read_b64_tr_b16 v[42:43], v20 offset:1024
    ds_read_b128 v[32:35], v14 offset:0
    ds_read_b64_tr_b16 v[44:45], v21 offset:0
    ds_read_b64_tr_b16 v[46:47], v21 offset:1024
    ds_read_b128 v[36:39], v14 offset:4096
    ds_read_b64_tr_b16 v[56:57], v20 offset:4096
    ds_read_b64_tr_b16 v[58:59], v20 offset:5120
    ds_read_b128 v[48:51], v15 offset:0
    ds_read_b64_tr_b16 v[60:61], v21 offset:4096
    ds_read_b64_tr_b16 v[62:63], v21 offset:5120
    ds_read_b128 v[52:55], v15 offset:4096
    ds_read_b64_tr_b16 v[72:73], v20 offset:8192
    ds_read_b64_tr_b16 v[74:75], v20 offset:9216
    ds_read_b128 v[64:67], v16 offset:0
    ds_read_b64_tr_b16 v[76:77], v21 offset:8192
    ds_read_b64_tr_b16 v[78:79], v21 offset:9216
    ds_read_b128 v[68:71], v16 offset:4096
p1qk_loop:
    s_waitcnt lgkmcnt(12)
    v_mfma_f32_32x32x16_bf16 v[96:111], v[40:43], v[32:35], v[96:111]
    ds_read_b64_tr_b16 v[88:89], v20 offset:12288
    ds_read_b64_tr_b16 v[90:91], v20 offset:13312
    s_add_u32 s40, s40, 0x8000
    s_and_b32 s40, s40, 0x1ffff
    v_xor_b32 v20, s40, v18
    v_mfma_f32_32x32x16_bf16 v[112:127], v[44:47], v[32:35], v[112:127]
    ds_read_b128 v[80:83], v17 offset:0
    v_xor_b32 v14, s40, v10
    v_xor_b32 v15, s40, v11
    v_mfma_f32_32x32x16_bf16 v[128:143], v[40:43], v[36:39], v[128:143]
    ds_read_b64_tr_b16 v[92:93], v21 offset:12288
    ds_read_b64_tr_b16 v[94:95], v21 offset:13312
    v_xor_b32 v21, s40, v19
    v_xor_b32 v16, s40, v12
    v_mfma_f32_32x32x16_bf16 v[144:159], v[44:47], v[36:39], v[144:159]
    ds_read_b128 v[84:87], v17 offset:4096
    v_xor_b32 v17, s40, v13
    s_sub_u32 s39, s39, 1
    s_cbranch_scc1 p1qk_last
    s_barrier
    s_waitcnt lgkmcnt(12)
    v_mfma_f32_32x32x16_bf16 v[96:111], v[56:59], v[48:51], v[96:111]
    ds_read_b64_tr_b16 v[40:41], v20 offset:0
    ds_read_b64_tr_b16 v[42:43], v20 offset:1024
    v_mfma_f32_32x32x16_bf16 v[112:127], v[60:63], v[48:51], v[112:127]
    ds_read_b128 v[32:35], v14 offset:0
    v_mfma_f32_32x32x16_bf16 v[128:143], v[56:59], v[52:55], v[128:143]
    ds_read_b64_tr_b16 v[44:45], v21 offset:0
    ds_read_b64_tr_b16 v[46:47], v21 offset:1024
    v_mfma_f32_32x32x16_bf16 v[144:159], v[60:63], v[52:55], v[144:159]
    ds_read_b128 v[36:39], v14 offset:4096
    s_waitcnt lgkmcnt(12)
    v_mfma_f32_32x32x16_bf16 v[96:111], v[72:75], v[64:67], v[96:111]
    ds_read_b64_tr_b16 v[56:57], v20 offset:4096
    ds_read_b64_tr_b16 v[58:59], v20 offset:5120
    v_mfma_f32_32x32x16_bf16 v[112:127], v[76:79], v[64:67], v[112:127]
    ds_read_b128 v[48:51], v15 offset:0
    v_mfma_f32_32x32x16_bf16 v[128:143], v[72:75], v[68:71], v[128:143]
    ds_read_b64_tr_b16 v[60:61], v21 offset:4096
    ds_read_b64_tr_b16 v[62:63], v21 offset:5120
    v_mfma_f32_32x32x16_bf16 v[144:159], v[76:79], v[68:71], v[144:159]
    ds_read_b128 v[52:55], v15 offset:4096
    s_waitcnt lgkmcnt(12)
    v_mfma_f32_32x32x16_bf16 v[96:111], v[88:91], v[80:83], v[96:111]
    ds_read_b64_tr_b16 v[72:73], v20 offset:8192
    ds_read_b64_tr_b16 v[74:75], v20 offset:9216
    v_mfma_f32_32x32x16_bf16 v[112:127], v[92:95], v[80:83], v[112:127]
    ds_read_b128 v[64:67], v16 offset:0
    v_mfma_f32_32x32x16_bf16 v[128:143], v[88:91], v[84:87], v[128:143]
    ds_read_b64_tr_b16 v[76:77], v21 offset:8192
    ds_read_b64_tr_b16 v[78:79], v21 offset:9216
    v_mfma_f32_32x32x16_bf16 v[144:159], v[92:95], v[84:87], v[144:159]
    ds_read_b128 v[68:71], v16 offset:4096
    s_branch p1qk_loop
p1qk_last:
    s_waitcnt lgkmcnt(12)
    v_mfma_f32_32x32x16_bf16 v[96:111], v[56:59], v[48:51], v[96:111]
    v_mfma_f32_32x32x16_bf16 v[112:127], v[60:63], v[48:51], v[112:127]
    v_mfma_f32_32x32x16_bf16 v[128:143], v[56:59], v[52:55], v[128:143]
    v_mfma_f32_32x32x16_bf16 v[144:159], v[60:63], v[52:55], v[144:159]
    s_waitcnt lgkmcnt(6)
    v_mfma_f32_32x32x16_bf16 v[96:111], v[72:75], v[64:67], v[96:111]
    v_mfma_f32_32x32x16_bf16 v[112:127], v[76:79], v[64:67], v[112:127]
    v_mfma_f32_32x32x16_bf16 v[128:143], v[72:75], v[68:71], v[128:143]
    v_mfma_f32_32x32x16_bf16 v[144:159], v[76:79], v[68:71], v[144:159]
    s_waitcnt lgkmcnt(0)
    s_mov_b64 exec, 1
    ds_add_u32 v22, v23 offset:32
    s_mov_b64 exec, -1
    v_mfma_f32_32x32x16_bf16 v[96:111], v[88:91], v[80:83], v[96:111]
    v_mfma_f32_32x32x16_bf16 v[112:127], v[92:95], v[80:83], v[112:127]
    v_mfma_f32_32x32x16_bf16 v[128:143], v[88:91], v[84:87], v[128:143]
    v_mfma_f32_32x32x16_bf16 v[144:159], v[92:95], v[84:87], v[144:159]
p1qk_fin_spin:
    ds_read_b32 v6, v22 offset:28
    s_waitcnt lgkmcnt(0)
    v_readfirstlane_b32 s25, v6
    s_cmp_ge_u32 s25, 5
    s_cbranch_scc1 p1qk_fin_done
    s_sleep 1
    s_sub_u32 s68, s68, 1
    s_cbranch_scc0 p1qk_fin_spin
    s_mov_b32 s68, 0
p1qk_fin_done:
    s_lshl_b32 s25, s37, 8
    s_add_u32 s25, s25, 152064
    v_lshl_add_u32 v3, v1, 2, s25
    ds_read_b32 v4, v3 offset:0
    ds_read_b32 v5, v3 offset:512
    ds_read_b32 v6, v3 offset:128
    ds_read_b32 v7, v3 offset:640
    v_lshl_add_u32 v3, v2, 4, s41
    ds_read_b128 v[32:35], v3 offset:1024
    ds_read_b128 v[36:39], v3 offset:1056
    ds_read_b128 v[40:43], v3 offset:1088
    ds_read_b128 v[44:47], v3 offset:1120
    ds_read_b128 v[48:51], v3 offset:1152
    ds_read_b128 v[52:55], v3 offset:1184
    ds_read_b128 v[56:59], v3 offset:1216
    ds_read_b128 v[60:63], v3 offset:1248
    s_waitcnt lgkmcnt(7)
    v_fmac_f32 v96, v32, v4
    v_fmac_f32 v97, v33, v4
    v_fmac_f32 v98, v34, v4
    v_fmac_f32 v99, v35, v4
    v_fmac_f32 v128, v32, v6
    v_fmac_f32 v129, v33, v6
    v_fmac_f32 v130, v34, v6
    v_fmac_f32 v131, v35, v6
    v_mul_f32 v96, v96, v5
    v_mul_f32 v97, v97, v5
    v_mul_f32 v98, v98, v5
    v_mul_f32 v99, v99, v5
    v_mul_f32 v128, v128, v7
    v_mul_f32 v129, v129, v7
    v_mul_f32 v130, v130, v7
    v_mul_f32 v131, v131, v7
    v_cvt_pk_bf16_f32 v32, v96, v97
    v_cvt_pk_bf16_f32 v33, v98, v99
    v_cvt_pk_bf16_f32 v34, v128, v129
    v_cvt_pk_bf16_f32 v35, v130, v131
    s_bitcmp1_b32 s69, 0
    s_cbranch_scc1 p1qk_t0
    v_permlane32_swap_b32 v32, v34
    v_permlane32_swap_b32 v33, v35
    buffer_store_dwordx4 v[32:35], v25, s[8:11], s50 offen sc1
p1qk_u0:
    s_waitcnt lgkmcnt(6)
    v_fmac_f32 v100, v36, v4
    v_fmac_f32 v101, v37, v4
    v_fmac_f32 v102, v38, v4
    v_fmac_f32 v103, v39, v4
    v_fmac_f32 v132, v36, v6
    v_fmac_f32 v133, v37, v6
    v_fmac_f32 v134, v38, v6
    v_fmac_f32 v135, v39, v6
    v_mul_f32 v100, v100, v5
    v_mul_f32 v101, v101, v5
    v_mul_f32 v102, v102, v5
    v_mul_f32 v103, v103, v5
    v_mul_f32 v132, v132, v7
    v_mul_f32 v133, v133, v7
    v_mul_f32 v134, v134, v7
    v_mul_f32 v135, v135, v7
    v_cvt_pk_bf16_f32 v36, v100, v101
    v_cvt_pk_bf16_f32 v37, v102, v103
    v_cvt_pk_bf16_f32 v38, v132, v133
    v_cvt_pk_bf16_f32 v39, v134, v135
    s_bitcmp1_b32 s69, 1
    s_cbranch_scc1 p1qk_t1
    v_permlane32_swap_b32 v36, v38
    v_permlane32_swap_b32 v37, v39
    buffer_store_dwordx4 v[36:39], v25, s[8:11], s51 offen sc1
p1qk_u1:
    s_waitcnt lgkmcnt(5)
    v_fmac_f32 v104, v40, v4
    v_fmac_f32 v105, v41, v4
    v_fmac_f32 v106, v42, v4
    v_fmac_f32 v107, v43, v4
    v_fmac_f32 v136, v40, v6
    v_fmac_f32 v137, v41, v6
    v_fmac_f32 v138, v42, v6
    v_fmac_f32 v139, v43, v6
    v_mul_f32 v104, v104, v5
    v_mul_f32 v105, v105, v5
    v_mul_f32 v106, v106, v5
    v_mul_f32 v107, v107, v5
    v_mul_f32 v136, v136, v7
    v_mul_f32 v137, v137, v7
    v_mul_f32 v138, v138, v7
    v_mul_f32 v139, v139, v7
    v_cvt_pk_bf16_f32 v40, v104, v105
    v_cvt_pk_bf16_f32 v41, v106, v107
    v_cvt_pk_bf16_f32 v42, v136, v137
    v_cvt_pk_bf16_f32 v43, v138, v139
    s_bitcmp1_b32 s69, 2
    s_cbranch_scc1 p1qk_t2
    v_permlane32_swap_b32 v40, v42
    v_permlane32_swap_b32 v41, v43
    buffer_store_dwordx4 v[40:43], v25, s[8:11], s52 offen sc1
p1qk_u2:
    s_waitcnt lgkmcnt(4)
    v_fmac_f32 v108, v44, v4
    v_fmac_f32 v109, v45, v4
    v_fmac_f32 v110, v46, v4
    v_fmac_f32 v111, v47, v4
    v_fmac_f32 v140, v44, v6
    v_fmac_f32 v141, v45, v6
    v_fmac_f32 v142, v46, v6
    v_fmac_f32 v143, v47, v6
    v_mul_f32 v108, v108, v5
    v_mul_f32 v109, v109, v5
    v_mul_f32 v110, v110, v5
    v_mul_f32 v111, v111, v5
    v_mul_f32 v140, v140, v7
    v_mul_f32 v141, v141, v7
    v_mul_f32 v142, v142, v7
    v_mul_f32 v143, v143, v7
    v_cvt_pk_bf16_f32 v44, v108, v109
    v_cvt_pk_bf16_f32 v45, v110, v111
    v_cvt_pk_bf16_f32 v46, v140, v141
    v_cvt_pk_bf16_f32 v47, v142, v143
    s_bitcmp1_b32 s69, 3
    s_cbranch_scc1 p1qk_t3
    v_permlane32_swap_b32 v44, v46
    v_permlane32_swap_b32 v45, v47
    buffer_store_dwordx4 v[44:47], v25, s[8:11], s53 offen sc1
p1qk_u3:
    s_waitcnt lgkmcnt(3)
    v_fmac_f32 v112, v48, v4
    v_fmac_f32 v113, v49, v4
    v_fmac_f32 v114, v50, v4
    v_fmac_f32 v115, v51, v4
    v_fmac_f32 v144, v48, v6
    v_fmac_f32 v145, v49, v6
    v_fmac_f32 v146, v50, v6
    v_fmac_f32 v147, v51, v6
    v_mul_f32 v112, v112, v5
    v_mul_f32 v113, v113, v5
    v_mul_f32 v114, v114, v5
    v_mul_f32 v115, v115, v5
    v_mul_f32 v144, v144, v7
    v_mul_f32 v145, v145, v7
    v_mul_f32 v146, v146, v7
    v_mul_f32 v147, v147, v7
    v_cvt_pk_bf16_f32 v48, v112, v113
    v_cvt_pk_bf16_f32 v49, v114, v115
    v_cvt_pk_bf16_f32 v50, v144, v145
    v_cvt_pk_bf16_f32 v51, v146, v147
    s_bitcmp1_b32 s69, 4
    s_cbranch_scc1 p1qk_t4
    v_permlane32_swap_b32 v48, v50
    v_permlane32_swap_b32 v49, v51
    buffer_store_dwordx4 v[48:51], v25, s[8:11], s54 offen sc1
p1qk_u4:
    s_waitcnt lgkmcnt(2)
    v_fmac_f32 v116, v52, v4
    v_fmac_f32 v117, v53, v4
    v_fmac_f32 v118, v54, v4
    v_fmac_f32 v119, v55, v4
    v_fmac_f32 v148, v52, v6
    v_fmac_f32 v149, v53, v6
    v_fmac_f32 v150, v54, v6
    v_fmac_f32 v151, v55, v6
    v_mul_f32 v116, v116, v5
    v_mul_f32 v117, v117, v5
    v_mul_f32 v118, v118, v5
    v_mul_f32 v119, v119, v5
    v_mul_f32 v148, v148, v7
    v_mul_f32 v149, v149, v7
    v_mul_f32 v150, v150, v7
    v_mul_f32 v151, v151, v7
    v_cvt_pk_bf16_f32 v52, v116, v117
    v_cvt_pk_bf16_f32 v53, v118, v119
    v_cvt_pk_bf16_f32 v54, v148, v149
    v_cvt_pk_bf16_f32 v55, v150, v151
    s_bitcmp1_b32 s69, 5
    s_cbranch_scc1 p1qk_t5
    v_permlane32_swap_b32 v52, v54
    v_permlane32_swap_b32 v53, v55
    buffer_store_dwordx4 v[52:55], v25, s[8:11], s55 offen sc1
p1qk_u5:
    s_waitcnt lgkmcnt(1)
    v_fmac_f32 v120, v56, v4
    v_fmac_f32 v121, v57, v4
    v_fmac_f32 v122, v58, v4
    v_fmac_f32 v123, v59, v4
    v_fmac_f32 v152, v56, v6
    v_fmac_f32 v153, v57, v6
    v_fmac_f32 v154, v58, v6
    v_fmac_f32 v155, v59, v6
    v_mul_f32 v120, v120, v5
    v_mul_f32 v121, v121, v5
    v_mul_f32 v122, v122, v5
    v_mul_f32 v123, v123, v5
    v_mul_f32 v152, v152, v7
    v_mul_f32 v153, v153, v7
    v_mul_f32 v154, v154, v7
    v_mul_f32 v155, v155, v7
    v_cvt_pk_bf16_f32 v56, v120, v121
    v_cvt_pk_bf16_f32 v57, v122, v123
    v_cvt_pk_bf16_f32 v58, v152, v153
    v_cvt_pk_bf16_f32 v59, v154, v155
    s_bitcmp1_b32 s69, 6
    s_cbranch_scc1 p1qk_t6
    v_permlane32_swap_b32 v56, v58
    v_permlane32_swap_b32 v57, v59
    buffer_store_dwordx4 v[56:59], v25, s[8:11], s66 offen sc1
p1qk_u6:
    s_waitcnt lgkmcnt(0)
    v_fmac_f32 v124, v60, v4
    v_fmac_f32 v125, v61, v4
    v_fmac_f32 v126, v62, v4
    v_fmac_f32 v127, v63, v4
    v_fmac_f32 v156, v60, v6
    v_fmac_f32 v157, v61, v6
    v_fmac_f32 v158, v62, v6
    v_fmac_f32 v159, v63, v6
    v_mul_f32 v124, v124, v5
    v_mul_f32 v125, v125, v5
    v_mul_f32 v126, v126, v5
    v_mul_f32 v127, v127, v5
    v_mul_f32 v156, v156, v7
    v_mul_f32 v157, v157, v7
    v_mul_f32 v158, v158, v7
    v_mul_f32 v159, v159, v7
    v_cvt_pk_bf16_f32 v60, v124, v125
    v_cvt_pk_bf16_f32 v61, v126, v127
    v_cvt_pk_bf16_f32 v62, v156, v157
    v_cvt_pk_bf16_f32 v63, v158, v159
    s_bitcmp1_b32 s69, 7
    s_cbranch_scc1 p1qk_t7
    v_permlane32_swap_b32 v60, v62
    v_permlane32_swap_b32 v61, v63
    buffer_store_dwordx4 v[60:63], v25, s[8:11], s67 offen sc1
p1qk_u7:
    s_branch p1_pub
p1qk_t0:
    buffer_store_dwordx4 v[32:35], v26, s[8:11], s50 offen sc1
    s_branch p1qk_u0
p1qk_t1:
    buffer_store_dwordx4 v[36:39], v26, s[8:11], s51 offen sc1
    s_branch p1qk_u1
p1qk_t2:
    buffer_store_dwordx4 v[40:43], v26, s[8:11], s52 offen sc1
    s_branch p1qk_u2
p1qk_t3:
    buffer_store_dwordx4 v[44:47], v26, s[8:11], s53 offen sc1
    s_branch p1qk_u3
p1qk_t4:
    buffer_store_dwordx4 v[48:51], v26, s[8:11], s54 offen sc1
    s_branch p1qk_u4
p1qk_t5:
    buffer_store_dwordx4 v[52:55], v26, s[8:11], s55 offen sc1
    s_branch p1qk_u5
p1qk_t6:
    buffer_store_dwordx4 v[56:59], v26, s[8:11], s66 offen sc1
    s_branch p1qk_u6
p1qk_t7:
    buffer_store_dwordx4 v[60:63], v26, s[8:11], s67 offen sc1
    s_branch p1_pub
p1_v:
    s_sub_u32 s25, s75, 10
    s_lshl_b32 s25, s25, 7
    s_lshl_b32 s26, s38, 6
    s_add_u32 s25, s25, s26
    s_mov_b32 s44, 163840
    s_movk_i32 s45, -20
    v_mul_u32_u24 v3, 320, v2
    v_add_u32 v4, s25, v1
    v_mul_u32_u24 v5, 205, v4
    v_lshrrev_b32 v5, 12, v5
    v_mad_i32_i24 v4, v5, s45, v4
    v_mad_u32_u24 v5, v5, s44, v3
    v_lshl_add_u32 v25, v4, 4, v5
    v_add_u32 v4, s25, v1
    v_add_u32 v4, 32, v4
    v_mul_u32_u24 v5, 205, v4
    v_lshrrev_b32 v5, 12, v5
    v_mad_i32_i24 v4, v5, s45, v4
    v_mad_u32_u24 v5, v5, s44, v3
    v_lshl_add_u32 v26, v4, 4, v5
    s_mul_i32 s44, s43, 5120
    s_add_u32 s44, s44, 0x280a00
    s_barrier
    ds_read_b64_tr_b16 v[40:41], v20 offset:0
    ds_read_b64_tr_b16 v[42:43], v20 offset:1024
    ds_read_b128 v[32:35], v14 offset:0
    ds_read_b64_tr_b16 v[44:45], v21 offset:0
    ds_read_b64_tr_b16 v[46:47], v21 offset:1024
    ds_read_b128 v[36:39], v14 offset:4096
    ds_read_b64_tr_b16 v[56:57], v20 offset:4096
    ds_read_b64_tr_b16 v[58:59], v20 offset:5120
    ds_read_b128 v[48:51], v15 offset:0
    ds_read_b64_tr_b16 v[60:61], v21 offset:4096
    ds_read_b64_tr_b16 v[62:63], v21 offset:5120
    ds_read_b128 v[52:55], v15 offset:4096
    ds_read_b64_tr_b16 v[72:73], v20 offset:8192
    ds_read_b64_tr_b16 v[74:75], v20 offset:9216
    ds_read_b128 v[64:67], v16 offset:0
    ds_read_b64_tr_b16 v[76:77], v21 offset:8192
    ds_read_b64_tr_b16 v[78:79], v21 offset:9216
    ds_read_b128 v[68:71], v16 offset:4096
p1v_loop:
    s_waitcnt lgkmcnt(12)
    v_mfma_f32_32x32x16_bf16 v[96:111], v[32:35], v[40:43], v[96:111]
    ds_read_b64_tr_b16 v[88:89], v20 offset:12288
    ds_read_b64_tr_b16 v[90:91], v20 offset:13312
    s_add_u32 s40, s40, 0x8000
    s_and_b32 s40, s40, 0x1ffff
    v_xor_b32 v20, s40, v18
    v_mfma_f32_32x32x16_bf16 v[112:127], v[32:35], v[44:47], v[112:127]
    ds_read_b128 v[80:83], v17 offset:0
    v_xor_b32 v14, s40, v10
    v_xor_b32 v15, s40, v11
    v_mfma_f32_32x32x16_bf16 v[128:143], v[36:39], v[40:43], v[128:143]
    ds_read_b64_tr_b16 v[92:93], v21 offset:12288
    ds_read_b64_tr_b16 v[94:95], v21 offset:13312
    v_xor_b32 v21, s40, v19
    v_xor_b32 v16, s40, v12
    v_mfma_f32_32x32x16_bf16 v[144:159], v[36:39], v[44:47], v[144:159]
    ds_read_b128 v[84:87], v17 offset:4096
    v_xor_b32 v17, s40, v13
    s_sub_u32 s39, s39, 1
    s_cbranch_scc1 p1v_last
    s_barrier
    s_waitcnt lgkmcnt(12)
    v_mfma_f32_32x32x16_bf16 v[96:111], v[48:51], v[56:59], v[96:111]
    ds_read_b64_tr_b16 v[40:41], v20 offset:0
    ds_read_b64_tr_b16 v[42:43], v20 offset:1024
    v_mfma_f32_32x32x16_bf16 v[112:127], v[48:51], v[60:63], v[112:127]
    ds_read_b128 v[32:35], v14 offset:0
    v_mfma_f32_32x32x16_bf16 v[128:143], v[52:55], v[56:59], v[128:143]
    ds_read_b64_tr_b16 v[44:45], v21 offset:0
    ds_read_b64_tr_b16 v[46:47], v21 offset:1024
    v_mfma_f32_32x32x16_bf16 v[144:159], v[52:55], v[60:63], v[144:159]
    ds_read_b128 v[36:39], v14 offset:4096
    s_waitcnt lgkmcnt(12)
    v_mfma_f32_32x32x16_bf16 v[96:111], v[64:67], v[72:75], v[96:111]
    ds_read_b64_tr_b16 v[56:57], v20 offset:4096
    ds_read_b64_tr_b16 v[58:59], v20 offset:5120
    v_mfma_f32_32x32x16_bf16 v[112:127], v[64:67], v[76:79], v[112:127]
    ds_read_b128 v[48:51], v15 offset:0
    v_mfma_f32_32x32x16_bf16 v[128:143], v[68:71], v[72:75], v[128:143]
    ds_read_b64_tr_b16 v[60:61], v21 offset:4096
    ds_read_b64_tr_b16 v[62:63], v21 offset:5120
    v_mfma_f32_32x32x16_bf16 v[144:159], v[68:71], v[76:79], v[144:159]
    ds_read_b128 v[52:55], v15 offset:4096
    s_waitcnt lgkmcnt(12)
    v_mfma_f32_32x32x16_bf16 v[96:111], v[80:83], v[88:91], v[96:111]
    ds_read_b64_tr_b16 v[72:73], v20 offset:8192
    ds_read_b64_tr_b16 v[74:75], v20 offset:9216
    v_mfma_f32_32x32x16_bf16 v[112:127], v[80:83], v[92:95], v[112:127]
    ds_read_b128 v[64:67], v16 offset:0
    v_mfma_f32_32x32x16_bf16 v[128:143], v[84:87], v[88:91], v[128:143]
    ds_read_b64_tr_b16 v[76:77], v21 offset:8192
    ds_read_b64_tr_b16 v[78:79], v21 offset:9216
    v_mfma_f32_32x32x16_bf16 v[144:159], v[84:87], v[92:95], v[144:159]
    ds_read_b128 v[68:71], v16 offset:4096
    s_branch p1v_loop
p1v_last:
    s_waitcnt lgkmcnt(12)
    v_mfma_f32_32x32x16_bf16 v[96:111], v[48:51], v[56:59], v[96:111]
    v_mfma_f32_32x32x16_bf16 v[112:127], v[48:51], v[60:63], v[112:127]
    v_mfma_f32_32x32x16_bf16 v[128:143], v[52:55], v[56:59], v[128:143]
    v_mfma_f32_32x32x16_bf16 v[144:159], v[52:55], v[60:63], v[144:159]
    s_waitcnt lgkmcnt(6)
    v_mfma_f32_32x32x16_bf16 v[96:111], v[64:67], v[72:75], v[96:111]
    v_mfma_f32_32x32x16_bf16 v[112:127], v[64:67], v[76:79], v[112:127]
    v_mfma_f32_32x32x16_bf16 v[128:143], v[68:71], v[72:75], v[128:143]
    v_mfma_f32_32x32x16_bf16 v[144:159], v[68:71], v[76:79], v[144:159]
    s_waitcnt lgkmcnt(0)
    s_mov_b64 exec, 1
    ds_add_u32 v22, v23 offset:32
    s_mov_b64 exec, -1
    v_mfma_f32_32x32x16_bf16 v[96:111], v[80:83], v[88:91], v[96:111]
    v_mfma_f32_32x32x16_bf16 v[112:127], v[80:83], v[92:95], v[112:127]
    v_mfma_f32_32x32x16_bf16 v[128:143], v[84:87], v[88:91], v[128:143]
    v_mfma_f32_32x32x16_bf16 v[144:159], v[84:87], v[92:95], v[144:159]
p1v_fin_spin:
    ds_read_b32 v6, v22 offset:28
    s_waitcnt lgkmcnt(0)
    v_readfirstlane_b32 s25, v6
    s_cmp_ge_u32 s25, 5
    s_cbranch_scc1 p1v_fin_done
    s_sleep 1
    s_sub_u32 s68, s68, 1
    s_cbranch_scc0 p1v_fin_spin
    s_mov_b32 s68, 0
p1v_fin_done:
    v_lshl_add_u32 v3, v1, 2, s41
    ds_read_b32 v4, v3 offset:1024
    ds_read_b32 v5, v3 offset:1152
    s_lshl_b32 s25, s37, 8
    s_add_u32 s25, s25, 152064
    v_lshl_add_u32 v3, v2, 4, s25
    ds_read_b128 v[32:35], v3 offset:0
    ds_read_b128 v[48:51], v3 offset:512
    ds_read_b128 v[36:39], v3 offset:32
    ds_read_b128 v[52:55], v3 offset:544
    ds_read_b128 v[40:43], v3 offset:64
    ds_read_b128 v[56:59], v3 offset:576
    ds_read_b128 v[44:47], v3 offset:96
    ds_read_b128 v[60:63], v3 offset:608
    ds_read_b128 v[64:67], v3 offset:128
    ds_read_b128 v[80:83], v3 offset:640
    ds_read_b128 v[68:71], v3 offset:160
    ds_read_b128 v[84:87], v3 offset:672
    s_waitcnt lgkmcnt(8)
    v_fmac_f32 v96, v32, v4
    v_fmac_f32 v97, v33, v4
    v_fmac_f32 v98, v34, v4
    v_fmac_f32 v99, v35, v4
    v_fmac_f32 v100, v36, v4
    v_fmac_f32 v101, v37, v4
    v_fmac_f32 v102, v38, v4
    v_fmac_f32 v103, v39, v4
    v_mul_f32 v96, v96, v48
    v_mul_f32 v97, v97, v49
    v_mul_f32 v98, v98, v50
    v_mul_f32 v99, v99, v51
    v_mul_f32 v100, v100, v52
    v_mul_f32 v101, v101, v53
    v_mul_f32 v102, v102, v54
    v_mul_f32 v103, v103, v55
    v_cvt_pk_bf16_f32 v96, v96, v97
    v_cvt_pk_bf16_f32 v97, v98, v99
    v_cvt_pk_bf16_f32 v98, v100, v101
    v_cvt_pk_bf16_f32 v99, v102, v103
    buffer_store_dwordx4 v[96:99], v25, s[8:11], s44 offen offset:0 sc1
    v_fmac_f32 v112, v32, v5
    v_fmac_f32 v113, v33, v5
    v_fmac_f32 v114, v34, v5
    v_fmac_f32 v115, v35, v5
    v_fmac_f32 v116, v36, v5
    v_fmac_f32 v117, v37, v5
    v_fmac_f32 v118, v38, v5
    v_fmac_f32 v119, v39, v5
    v_mul_f32 v112, v112, v48
    v_mul_f32 v113, v113, v49
    v_mul_f32 v114, v114, v50
    v_mul_f32 v115, v115, v51
    v_mul_f32 v116, v116, v52
    v_mul_f32 v117, v117, v53
    v_mul_f32 v118, v118, v54
    v_mul_f32 v119, v119, v55
    v_cvt_pk_bf16_f32 v112, v112, v113
    v_cvt_pk_bf16_f32 v113, v114, v115
    v_cvt_pk_bf16_f32 v114, v116, v117
    v_cvt_pk_bf16_f32 v115, v118, v119
    buffer_store_dwordx4 v[112:115], v26, s[8:11], s44 offen offset:0 sc1
    ds_read_b128 v[72:75], v3 offset:192
    ds_read_b128 v[88:91], v3 offset:704
    ds_read_b128 v[76:79], v3 offset:224
    ds_read_b128 v[92:95], v3 offset:736
    s_waitcnt lgkmcnt(8)
    v_fmac_f32 v104, v40, v4
    v_fmac_f32 v105, v41, v4
    v_fmac_f32 v106, v42, v4
    v_fmac_f32 v107, v43, v4
    v_fmac_f32 v108, v44, v4
    v_fmac_f32 v109, v45, v4
    v_fmac_f32 v110, v46, v4
    v_fmac_f32 v111, v47, v4
    v_mul_f32 v104, v104, v56
    v_mul_f32 v105, v105, v57
    v_mul_f32 v106, v106, v58
    v_mul_f32 v107, v107, v59
    v_mul_f32 v108, v108, v60
    v_mul_f32 v109, v109, v61
    v_mul_f32 v110, v110, v62
    v_mul_f32 v111, v111, v63
    v_cvt_pk_bf16_f32 v104, v104, v105
    v_cvt_pk_bf16_f32 v105, v106, v107
    v_cvt_pk_bf16_f32 v106, v108, v109
    v_cvt_pk_bf16_f32 v107, v110, v111
    buffer_store_dwordx4 v[104:107], v25, s[8:11], s44 offen offset:640 sc1
    v_fmac_f32 v120, v40, v5
    v_fmac_f32 v121, v41, v5
    v_fmac_f32 v122, v42, v5
    v_fmac_f32 v123, v43, v5
    v_fmac_f32 v124, v44, v5
    v_fmac_f32 v125, v45, v5
    v_fmac_f32 v126, v46, v5
    v_fmac_f32 v127, v47, v5
    v_mul_f32 v120, v120, v56
    v_mul_f32 v121, v121, v57
    v_mul_f32 v122, v122, v58
    v_mul_f32 v123, v123, v59
    v_mul_f32 v124, v124, v60
    v_mul_f32 v125, v125, v61
    v_mul_f32 v126, v126, v62
    v_mul_f32 v127, v127, v63
    v_cvt_pk_bf16_f32 v120, v120, v121
    v_cvt_pk_bf16_f32 v121, v122, v123
    v_cvt_pk_bf16_f32 v122, v124, v125
    v_cvt_pk_bf16_f32 v123, v126, v127
    buffer_store_dwordx4 v[120:123], v26, s[8:11], s44 offen offset:640 sc1
    s_waitcnt lgkmcnt(4)
    v_fmac_f32 v128, v64, v4
    v_fmac_f32 v129, v65, v4
    v_fmac_f32 v130, v66, v4
    v_fmac_f32 v131, v67, v4
    v_fmac_f32 v132, v68, v4
    v_fmac_f32 v133, v69, v4
    v_fmac_f32 v134, v70, v4
    v_fmac_f32 v135, v71, v4
    v_mul_f32 v128, v128, v80
    v_mul_f32 v129, v129, v81
    v_mul_f32 v130, v130, v82
    v_mul_f32 v131, v131, v83
    v_mul_f32 v132, v132, v84
    v_mul_f32 v133, v133, v85
    v_mul_f32 v134, v134, v86
    v_mul_f32 v135, v135, v87
    v_cvt_pk_bf16_f32 v128, v128, v129
    v_cvt_pk_bf16_f32 v129, v130, v131
    v_cvt_pk_bf16_f32 v130, v132, v133
    v_cvt_pk_bf16_f32 v131, v134, v135
    buffer_store_dwordx4 v[128:131], v25, s[8:11], s44 offen offset:1280 sc1
    v_fmac_f32 v144, v64, v5
    v_fmac_f32 v145, v65, v5
    v_fmac_f32 v146, v66, v5
    v_fmac_f32 v147, v67, v5
    v_fmac_f32 v148, v68, v5
    v_fmac_f32 v149, v69, v5
    v_fmac_f32 v150, v70, v5
    v_fmac_f32 v151, v71, v5
    v_mul_f32 v144, v144, v80
    v_mul_f32 v145, v145, v81
    v_mul_f32 v146, v146, v82
    v_mul_f32 v147, v147, v83
    v_mul_f32 v148, v148, v84
    v_mul_f32 v149, v149, v85
    v_mul_f32 v150, v150, v86
    v_mul_f32 v151, v151, v87
    v_cvt_pk_bf16_f32 v144, v144, v145
    v_cvt_pk_bf16_f32 v145, v146, v147
    v_cvt_pk_bf16_f32 v146, v148, v149
    v_cvt_pk_bf16_f32 v147, v150, v151
    buffer_store_dwordx4 v[144:147], v26, s[8:11], s44 offen offset:1280 sc1
    s_waitcnt lgkmcnt(0)
    v_fmac_f32 v136, v72, v4
    v_fmac_f32 v137, v73, v4
    v_fmac_f32 v138, v74, v4
    v_fmac_f32 v139, v75, v4
    v_fmac_f32 v140, v76, v4
    v_fmac_f32 v141, v77, v4
    v_fmac_f32 v142, v78, v4
    v_fmac_f32 v143, v79, v4
    v_mul_f32 v136, v136, v88
    v_mul_f32 v137, v137, v89
    v_mul_f32 v138, v138, v90
    v_mul_f32 v139, v139, v91
    v_mul_f32 v140, v140, v92
    v_mul_f32 v141, v141, v93
    v_mul_f32 v142, v142, v94
    v_mul_f32 v143, v143, v95
    v_cvt_pk_bf16_f32 v136, v136, v137
    v_cvt_pk_bf16_f32 v137, v138, v139
    v_cvt_pk_bf16_f32 v138, v140, v141
    v_cvt_pk_bf16_f32 v139, v142, v143
    buffer_store_dwordx4 v[136:139], v25, s[8:11], s44 offen offset:1920 sc1
    v_fmac_f32 v152, v72, v5
    v_fmac_f32 v153, v73, v5
    v_fmac_f32 v154, v74, v5
    v_fmac_f32 v155, v75, v5
    v_fmac_f32 v156, v76, v5
    v_fmac_f32 v157, v77, v5
    v_fmac_f32 v158, v78, v5
    v_fmac_f32 v159, v79, v5
    v_mul_f32 v152, v152, v88
    v_mul_f32 v153, v153, v89
    v_mul_f32 v154, v154, v90
    v_mul_f32 v155, v155, v91
    v_mul_f32 v156, v156, v92
    v_mul_f32 v157, v157, v93
    v_mul_f32 v158, v158, v94
    v_mul_f32 v159, v159, v95
    v_cvt_pk_bf16_f32 v152, v152, v153
    v_cvt_pk_bf16_f32 v153, v154, v155
    v_cvt_pk_bf16_f32 v154, v156, v157
    v_cvt_pk_bf16_f32 v155, v158, v159
    buffer_store_dwordx4 v[152:155], v26, s[8:11], s44 offen offset:1920 sc1
p1_pub:
    s_add_u32 s28, s75, 16
    s_lshl_b32 s28, s28, 8
    s_add_u32 s28, s28, 0x1200000
    s_waitcnt vmcnt(0)
    v_mov_b32 v5, 151552
    v_mov_b32 v6, 1
    s_mov_b64 exec, 1
    ds_add_rtn_u32 v7, v5, v6 offset:40
    s_waitcnt lgkmcnt(0)
    v_readfirstlane_b32 s25, v7
    s_cmp_lg_u32 s25, 3
    s_cbranch_scc1 p1_qa_nl
    buffer_atomic_add v6, off, s[8:11], s28
p1_qa_nl:
    s_mov_b64 exec, -1
    s_branch p2_attn
p1_spare:
    s_cmp_lg_u32 s2, 57
    s_cbranch_scc1 p1_spare_work
    s_cmp_lg_u32 s36, 0
    s_cbranch_scc1 p1_spare_work
    v_lshlrev_b32 v3, 8, v0
    v_mov_b32 v4, 0
    s_mov_b32 s25, 0x1200000
    buffer_store_dword v4, v3, s[8:11], s25 offen sc1
    s_add_u32 s25, s25, 0x4000
    buffer_store_dword v4, v3, s[8:11], s25 offen sc1
    s_add_u32 s25, s25, 0x4000
    s_mov_b32 s12, s72
    s_and_b32 s13, s73, 0xffff
    s_mov_b32 s14, 0x100
    s_mov_b32 s15, 0x00020000
    s_waitcnt vmcnt(0)
    s_mov_b64 exec, 1
    buffer_store_dword v23, off, s[12:15], 0 sc1
    s_mov_b64 exec, -1
p1_spare_work:
    s_barrier
    s_barrier
    s_barrier
    s_barrier
    s_barrier
    s_barrier
    s_barrier
    s_barrier
    s_barrier
    s_barrier
    v_mov_b32 v5, 151552
    v_mov_b32 v6, 1
    s_mov_b64 exec, 1
    ds_add_u32 v5, v6 offset:32
    s_mov_b64 exec, -1
    s_bfe_u32 s36, s24, 0x10003
    s_lshl_b32 s36, s36, 3
    s_add_u32 s36, s36, s23
    s_lshl_b32 s36, s36, 3
    s_add_u32 s36, s36, s22
    s_mov_b32 s12, s56
    s_and_b32 s13, s57, 0xffff
    s_mov_b32 s14, 0x600000
    s_mov_b32 s15, 0x00020000
    v_cmp_le_u32 vcc, 24, v0
    v_lshlrev_b32 v5, 7, v0
    v_min_u32 v5, 6080, v5
    s_and_b32 s25, s36, 3
    s_mul_i32 s25, s25, 512
    s_lshr_b32 s26, s36, 2
    s_mul_i32 s26, s26, 2
    s_add_u32 s25, s25, s26
    s_mul_i32 s25, s25, 3072
    buffer_load_dword v167, v5, s[12:15], s25 offen
    s_add_u32 s25, s25, 196608
    buffer_load_dword v167, v5, s[12:15], s25 offen
    s_add_u32 s25, s25, 196608
    buffer_load_dword v167, v5, s[12:15], s25 offen
    s_add_u32 s25, s25, 196608
    buffer_load_dword v167, v5, s[12:15], s25 offen
    s_add_u32 s25, s25, 196608
    buffer_load_dword v167, v5, s[12:15], s25 offen
    s_add_u32 s25, s25, 196608
    s_branch p2_attn
p2_attn:
    s_and_b32 s42, s22, 1
    s_lshr_b32 s41, s22, 1
    s_and_b32 s25, s24, 3
    s_lshl_b32 s39, s23, 2
    s_add_u32 s39, s39, s25
    s_mul_i32 s26, s39, 81920
    s_mul_i32 s25, s41, 20480
    s_add_u32 s25, s25, s26
    s_lshl_b32 s25, s25, 1
    s_add_u32 s44, s25, 0x280000
    s_mul_i32 s49, s22, 10240
    s_add_u32 s49, s49, 65536
    v_lshlrev_b32 v1, 4, v0
    v_add_u32 v160, 4096, v1
    s_and_b32 s25, s24, -4
    s_lshl_b32 s27, s42, 1
    s_add_u32 s40, s25, s27
    s_mul_i32 s25, s40, 2560
    s_add_u32 s28, s25, s26
    s_mov_b32 s32, -1
    s_mov_b32 s33, 0
    s_mov_b32 s30, 0x000fffff
    s_mov_b32 s31, 0x000fffff
    v_and_b32 v3, 31, v0
    v_lshlrev_b32 v2, 4, v3
    v_add_u32 v2, 2048, v2
    v_mov_b32 v24, 0
    v_mov_b32 v25, 0
    v_mov_b32 v26, 0
    v_mov_b32 v27, 0
    v_mov_b32 v28, 0
    v_mov_b32 v29, 0
    v_mov_b32 v30, 0
    v_mov_b32 v31, 0
    v_lshrrev_b32 v6, 5, v0
    v_mul_u32_u24 v163, 320, v6
    v_add_u32 v162, s49, v2
    v_add_u32 v161, s49, v1
    v_add_u32 v163, v163, v162
    v_add_u32 v163, 512, v163
    v_mov_b32 v4, 0xdddddddd
    v_cmp_eq_u32 vcc, 20, v3
    v_mov_b32 v7, 0x3f803f80
    v_mov_b32 v6, 0x3f80
    v_cndmask_b32 v48, 0, v7, vcc
    v_mov_b32 v49, v48
    v_mov_b32 v50, v48
    v_mov_b32 v51, v48
    v_mov_b32 v52, v48
    v_mov_b32 v53, v48
    v_mov_b32 v54, v48
    v_mov_b32 v55, v48
    v_mov_b32 v56, v48
    v_mov_b32 v57, v48
    v_mov_b32 v58, v48
    v_mov_b32 v59, v48
    v_mov_b32 v60, v48
    v_mov_b32 v61, v48
    v_mov_b32 v62, v48
    v_mov_b32 v63, v48
    v_mov_b32 v40, v7
    v_mov_b32 v41, v6
    v_mov_b32 v42, v7
    v_mov_b32 v43, v6
    s_lshl_b32 s46, s42, 2
    s_add_u32 s46, s46, 151552
    s_mov_b32 s43, 0
    s_mov_b32 s29, 0
    s_add_u32 s54, s44, 40960
    s_mov_b32 s66, 4
    s_lshr_b32 s36, s24, 2
    s_mul_i32 s36, s36, 0
    s_add_u32 s36, s36, s44
    s_add_u32 s25, s41, 0
    s_and_b32 s25, s25, 3
    s_lshr_b32 s26, s25, 1
    s_mul_i32 s26, s26, 2560
    s_add_u32 s26, s26, s28
    s_and_b32 s25, s25, 1
    s_lshl_b32 s27, s25, 3
    s_add_u32 s50, s27, s26
    s_lshl_b32 s25, s25, 10
    s_add_u32 s45, s26, s25
    s_add_u32 s25, s41, 1
    s_and_b32 s25, s25, 3
    s_lshr_b32 s26, s25, 1
    s_mul_i32 s26, s26, 2560
    s_add_u32 s26, s26, s28
    s_and_b32 s25, s25, 1
    s_lshl_b32 s27, s25, 3
    s_add_u32 s51, s27, s26
    s_lshl_b32 s25, s25, 10
    s_add_u32 s47, s26, s25
    s_add_u32 s25, s41, 2
    s_and_b32 s25, s25, 3
    s_lshr_b32 s26, s25, 1
    s_mul_i32 s26, s26, 2560
    s_add_u32 s26, s26, s28
    s_and_b32 s25, s25, 1
    s_lshl_b32 s27, s25, 3
    s_add_u32 s52, s27, s26
    s_lshl_b32 s25, s25, 10
    s_add_u32 s48, s26, s25
    s_add_u32 s25, s41, 3
    s_and_b32 s25, s25, 3
    s_lshr_b32 s26, s25, 1
    s_mul_i32 s26, s26, 2560
    s_add_u32 s26, s26, s28
    s_and_b32 s25, s25, 1
    s_lshl_b32 s27, s25, 3
    s_add_u32 s53, s27, s26
    s_lshl_b32 s25, s25, 10
    s_add_u32 s37, s26, s25
    s_sub_u32 s25, s41, 1
    s_and_b32 s25, s25, 3
    s_lshl_b32 s25, s25, 1
    s_add_u32 s25, s25, s42
    s_mul_i32 s25, s25, 10240
    s_add_u32 s25, s25, 65536
    v_add_u32 v164, s25, v1
    s_sub_u32 s25, s41, 2
    s_and_b32 s25, s25, 3
    s_lshl_b32 s25, s25, 1
    s_add_u32 s25, s25, s42
    s_mul_i32 s25, s25, 10240
    s_add_u32 s25, s25, 68608
    v_add_u32 v165, s25, v1
    s_sub_u32 s25, s41, 3
    s_and_b32 s25, s25, 3
    s_lshl_b32 s25, s25, 1
    s_add_u32 s25, s25, s42
    s_mul_i32 s25, s25, 10240
    s_add_u32 s25, s25, 71680
    v_add_u32 v166, s25, v1
    s_lshl_b32 s25, s40, 1
    s_add_u32 s25, s25, s41
    s_mul_i32 s25, s25, 40960
    s_add_u32 s25, s25, 0xc00000
    s_lshl_b32 s26, s39, 9
    s_add_u32 s55, s26, s25
    s_lshr_b32 s27, s39, 1
    s_lshl_b32 s27, s27, 8
    s_and_b32 s26, s39, 1
    s_lshl_b32 s26, s26, 3
    s_add_u32 s27, s27, s26
    s_add_u32 s27, s27, s25
    s_add_u32 s67, s27, 16384
    v_bfe_u32 v44, v0, 4, 1
    v_mul_u32_u24 v44, 20480, v44
    v_and_b32 v7, 15, v0
    v_lshl_add_u32 v44, v7, 4, v44
    v_lshrrev_b32 v7, 5, v0
    v_lshl_add_u32 v44, v7, 8, v44
    s_cmp_lg_u32 s22, 4
    s_cbranch_scc1 p2_wgo
    v_mov_b32 v5, 151552
p2_hok_spin:
    ds_read_b32 v6, v5 offset:52
    s_waitcnt lgkmcnt(0)
    v_readfirstlane_b32 s25, v6
    s_cmp_ge_u32 s25, 5
    s_cbranch_scc1 p2_hok_done
    s_sleep 4
    s_sub_u32 s68, s68, 1
    s_cbranch_scc0 p2_hok_spin
    s_mov_b32 s68, 0
p2_hok_done:
    s_cmp_lg_u32 s75, 15
    s_cselect_b32 s27, 4, 0
    v_mov_b32 v5, 151552
p2_qa_spin:
    ds_read_b32 v6, v5 offset:40
    s_waitcnt lgkmcnt(0)
    v_readfirstlane_b32 s25, v6
    s_cmp_ge_u32 s25, s27
    s_cbranch_scc1 p2_qa_done
    s_sleep 2
    s_sub_u32 s68, s68, 1
    s_cbranch_scc0 p2_qa_spin
    s_mov_b32 s68, 0
p2_qa_done:
    s_mul_i32 s25, s39, 20
    v_and_b32 v3, 1, v0
    v_mad_u32_u24 v3, v3, 19, s25
    v_lshrrev_b32 v3, 7, v3
    v_bfe_u32 v7, v0, 1, 2
    v_min_u32 v7, 2, v7
    v_mad_u32_u24 v3, v7, 5, v3
    v_add_lshl_u32 v3, v3, 16, 8
    s_setprio 3
    s_mov_b32 s26, 0x1200000
p2_q_poll:
    buffer_load_dword v6, v3, s[8:11], s26 offen sc1
    s_waitcnt vmcnt(0)
    v_cmp_gt_u32 vcc, 16, v6
    s_nop 4
    s_cbranch_vccz p2_q_go
    s_sleep 1
    s_sub_u32 s68, s68, 1
    s_cbranch_scc0 p2_q_poll
    s_mov_b32 s68, 0
p2_q_go:
    s_setprio 0
    v_mov_b32 v5, 151552
p2_p1_spin:
    ds_read_b32 v6, v5 offset:32
    s_waitcnt lgkmcnt(0)
    v_readfirstlane_b32 s25, v6
    s_cmp_ge_u32 s25, 8
    s_cbranch_scc1 p2_p1_done
    s_sleep 1
    s_sub_u32 s68, s68, 1
    s_cbranch_scc0 p2_p1_spin
    s_mov_b32 s68, 0
p2_p1_done:
    v_mov_b32 v5, 151552
    v_mov_b32 v6, 1
    s_mov_b64 exec, 1
    ds_add_u32 v5, v6 offset:44
    s_mov_b64 exec, -1
p2_wgo:
    v_mov_b32 v5, 151552
p2_go_spin:
    ds_read_b32 v6, v5 offset:44
    s_waitcnt lgkmcnt(0)
    v_readfirstlane_b32 s25, v6
    s_cmp_ge_u32 s25, 1
    s_cbranch_scc1 p2_go_done
    s_sleep 2
    s_sub_u32 s68, s68, 1
    s_cbranch_scc0 p2_go_spin
    s_mov_b32 s68, 0
p2_go_done:
    s_setprio 3
    s_add_u32 m0, s49, 0
    s_nop 0
    buffer_load_dwordx4 v1, s[8:11], s36 offen offset:0 lds
    buffer_load_dwordx4 v1, s[8:11], s36 offen offset:1024 lds
    buffer_load_dwordx4 v1, s[8:11], s36 offen offset:2048 lds
    buffer_load_dwordx4 v1, s[8:11], s36 offen offset:3072 lds
    s_add_u32 m0, s49, 4096
    s_nop 0
    buffer_load_dwordx4 v160, s[8:11], s36 offen lds
    s_setprio 0
    s_add_u32 s36, s36, 5120
    s_cmp_lg_u32 s36, s54
    s_cselect_b32 s36, s36, s44
    s_setprio 3
    buffer_load_dwordx4 v[8:11], v1, s[8:11], s45 offen sc1
    buffer_load_dwordx4 v[12:15], v1, s[8:11], s47 offen sc1
    buffer_load_dwordx4 v[16:19], v1, s[8:11], s48 offen sc1
    buffer_load_dwordx4 v[20:23], v1, s[8:11], s37 offen sc1
    s_mov_b64 exec, s[32:33]
    buffer_load_dwordx2 v[24:25], v2, s[8:11], s50 offen sc1
    buffer_load_dwordx2 v[26:27], v2, s[8:11], s51 offen sc1
    buffer_load_dwordx2 v[28:29], v2, s[8:11], s52 offen sc1
    buffer_load_dwordx2 v[30:31], v2, s[8:11], s53 offen sc1
    s_mov_b64 exec, -1
    s_setprio 3
    s_add_u32 m0, s49, 5120
    s_nop 0
    buffer_load_dwordx4 v1, s[8:11], s36 offen offset:0 lds
    buffer_load_dwordx4 v1, s[8:11], s36 offen offset:1024 lds
    buffer_load_dwordx4 v1, s[8:11], s36 offen offset:2048 lds
    buffer_load_dwordx4 v1, s[8:11], s36 offen offset:3072 lds
    s_add_u32 m0, s49, 9216
    s_nop 0
    buffer_load_dwordx4 v160, s[8:11], s36 offen lds
    s_setprio 0
    s_add_u32 s36, s36, 5120
    s_cmp_lg_u32 s36, s54
    s_cselect_b32 s36, s36, s44
p2_pass:
    v_mov_b32 v88, 0
    v_mov_b32 v89, 0
    v_mov_b32 v90, 0
    v_mov_b32 v91, 0
    v_mov_b32 v92, 0
    v_mov_b32 v93, 0
    v_mov_b32 v94, 0
    v_mov_b32 v95, 0
    s_mov_b32 s38, 3
    s_mov_b64 vcc, -1
    v_mfma_f32_32x32x16_bf16 v[96:111], v[88:91], v[88:91], 0
    v_mfma_f32_32x32x16_bf16 v[112:127], v[88:91], v[88:91], 0
    v_mfma_f32_32x32x16_bf16 v[128:143], v[88:91], v[88:91], 0
    v_mfma_f32_32x32x16_bf16 v[144:159], v[88:91], v[88:91], 0
    s_waitcnt vmcnt(5)
    s_mov_b64 exec, s[32:33]
    ds_read_b64 v[40:41], v162 offset:0
    s_mov_b64 exec, -1
    ds_read_b128 v[32:35], v161 offset:0
    s_mov_b64 exec, s[32:33]
    ds_read_b64 v[42:43], v162 offset:8
    s_mov_b64 exec, -1
    ds_read_b128 v[36:39], v161 offset:1024
    s_mov_b64 exec, s[30:31]
    ds_read_b128 v[48:51], v163 offset:0
    ds_read_b128 v[52:55], v163 offset:640
    s_mov_b64 exec, -1
    s_waitcnt lgkmcnt(4)
    v_mfma_f32_32x32x16_bf16 v[64:79], v[32:35], v[8:11], 0
    v_mfma_f32_32x32x8_bf16 v[64:79], v[40:41], v[24:25], v[64:79]
    s_nop 7
    s_nop 3
.p2align 6
p2_aloop:
    v_exp_f32 v64, v64
    v_exp_f32 v65, v65
    v_smfmac_f32_32x32x32_bf16 v[144:159], v[60:63], v[88:95], v4
    s_mov_b64 exec, s[30:31]
    ds_read_b128 v[56:59], v163 offset:1280
    ds_read_b128 v[60:63], v163 offset:1920
    s_mov_b64 exec, -1
    v_exp_f32 v66, v66
    v_exp_f32 v67, v67
    v_exp_f32 v68, v68
    v_exp_f32 v69, v69
    v_mfma_f32_32x32x16_bf16 v[80:95], v[32:35], v[12:15], 0
    v_exp_f32 v70, v70
    v_exp_f32 v71, v71
    v_exp_f32 v72, v72
    v_exp_f32 v73, v73
    v_mfma_f32_32x32x8_bf16 v[80:95], v[40:41], v[26:27], v[80:95]
    v_exp_f32 v74, v74
    v_exp_f32 v75, v75
    v_exp_f32 v76, v76
    v_exp_f32 v77, v77
    s_waitcnt lgkmcnt(2)
    v_smfmac_f32_32x32x32_bf16 v[96:111], v[48:51], v[64:71], v4
    v_exp_f32 v78, v78
    v_exp_f32 v79, v79
    v_exp_f32 v80, v80
    v_exp_f32 v81, v81
    v_smfmac_f32_32x32x32_bf16 v[96:111], v[52:55], v[72:79], v4
    s_waitcnt lgkmcnt(0)
    s_cbranch_vccz p2_skd0
    s_setprio 3
    s_add_u32 m0, s49, 0
    s_nop 0
    buffer_load_dwordx4 v1, s[8:11], s36 offen offset:0 lds
    buffer_load_dwordx4 v1, s[8:11], s36 offen offset:1024 lds
    buffer_load_dwordx4 v1, s[8:11], s36 offen offset:2048 lds
    buffer_load_dwordx4 v1, s[8:11], s36 offen offset:3072 lds
    s_add_u32 m0, s49, 4096
    s_nop 0
    buffer_load_dwordx4 v160, s[8:11], s36 offen lds
    s_setprio 0
    s_add_u32 s36, s36, 5120
    s_cmp_lg_u32 s36, s54
    s_cselect_b32 s36, s36, s44
p2_skd0:
    v_exp_f32 v82, v82
    v_exp_f32 v83, v83
    v_exp_f32 v84, v84
    v_exp_f32 v85, v85
    v_mfma_f32_32x32x16_bf16 v[64:79], v[32:35], v[16:19], 0
    v_exp_f32 v86, v86
    v_exp_f32 v87, v87
    v_exp_f32 v88, v88
    v_exp_f32 v89, v89
    v_mfma_f32_32x32x8_bf16 v[64:79], v[40:41], v[28:29], v[64:79]
    v_exp_f32 v90, v90
    v_exp_f32 v91, v91
    v_exp_f32 v92, v92
    v_exp_f32 v93, v93
    v_smfmac_f32_32x32x32_bf16 v[112:127], v[48:51], v[80:87], v4
    v_exp_f32 v94, v94
    v_exp_f32 v95, v95
    v_exp_f32 v64, v64
    v_exp_f32 v65, v65
    v_smfmac_f32_32x32x32_bf16 v[112:127], v[52:55], v[88:95], v4
    v_exp_f32 v66, v66
    v_exp_f32 v67, v67
    v_exp_f32 v68, v68
    v_exp_f32 v69, v69
    v_mfma_f32_32x32x16_bf16 v[80:95], v[32:35], v[20:23], 0
    v_exp_f32 v70, v70
    v_exp_f32 v71, v71
    v_exp_f32 v72, v72
    v_exp_f32 v73, v73
    v_mfma_f32_32x32x8_bf16 v[80:95], v[40:41], v[30:31], v[80:95]
    v_exp_f32 v74, v74
    v_exp_f32 v75, v75
    v_exp_f32 v76, v76
    v_exp_f32 v77, v77
    v_smfmac_f32_32x32x32_bf16 v[128:143], v[48:51], v[64:71], v4
    v_exp_f32 v78, v78
    v_exp_f32 v79, v79
    v_exp_f32 v80, v80
    v_exp_f32 v81, v81
    v_smfmac_f32_32x32x32_bf16 v[128:143], v[52:55], v[72:79], v4
    v_exp_f32 v82, v82
    v_exp_f32 v83, v83
    v_exp_f32 v84, v84
    v_exp_f32 v85, v85
    v_mfma_f32_32x32x16_bf16 v[64:79], v[36:39], v[8:11], 0
    v_exp_f32 v86, v86
    v_exp_f32 v87, v87
    v_exp_f32 v88, v88
    v_exp_f32 v89, v89
    v_mfma_f32_32x32x8_bf16 v[64:79], v[42:43], v[24:25], v[64:79]
    v_exp_f32 v90, v90
    v_exp_f32 v91, v91
    v_exp_f32 v92, v92
    v_exp_f32 v93, v93
    v_smfmac_f32_32x32x32_bf16 v[144:159], v[48:51], v[80:87], v4
    v_exp_f32 v94, v94
    v_exp_f32 v95, v95
    v_exp_f32 v64, v64
    v_exp_f32 v65, v65
    v_smfmac_f32_32x32x32_bf16 v[144:159], v[52:55], v[88:95], v4
    v_exp_f32 v66, v66
    v_exp_f32 v67, v67
    v_exp_f32 v68, v68
    v_exp_f32 v69, v69
    v_mfma_f32_32x32x16_bf16 v[80:95], v[36:39], v[12:15], 0
    v_exp_f32 v70, v70
    v_exp_f32 v71, v71
    v_exp_f32 v72, v72
    v_exp_f32 v73, v73
    v_mfma_f32_32x32x8_bf16 v[80:95], v[42:43], v[26:27], v[80:95]
    v_exp_f32 v74, v74
    v_exp_f32 v75, v75
    v_exp_f32 v76, v76
    v_exp_f32 v77, v77
    v_smfmac_f32_32x32x32_bf16 v[96:111], v[56:59], v[64:71], v4
    v_exp_f32 v78, v78
    v_exp_f32 v79, v79
    v_exp_f32 v80, v80
    v_exp_f32 v81, v81
    v_smfmac_f32_32x32x32_bf16 v[96:111], v[60:63], v[72:79], v4
    v_exp_f32 v82, v82
    v_exp_f32 v83, v83
    v_exp_f32 v84, v84
    v_exp_f32 v85, v85
    v_mfma_f32_32x32x16_bf16 v[64:79], v[36:39], v[16:19], 0
    v_exp_f32 v86, v86
    v_exp_f32 v87, v87
    v_exp_f32 v88, v88
    v_exp_f32 v89, v89
    v_mfma_f32_32x32x8_bf16 v[64:79], v[42:43], v[28:29], v[64:79]
    v_exp_f32 v90, v90
    v_exp_f32 v91, v91
    v_exp_f32 v92, v92
    v_exp_f32 v93, v93
    v_smfmac_f32_32x32x32_bf16 v[112:127], v[56:59], v[80:87], v4
    v_exp_f32 v94, v94
    v_exp_f32 v95, v95
    v_exp_f32 v64, v64
    v_exp_f32 v65, v65
    v_smfmac_f32_32x32x32_bf16 v[112:127], v[60:63], v[88:95], v4
    s_waitcnt vmcnt(5)
    s_cbranch_vccz p2_w00
p2_w00_b:
    s_mov_b64 exec, s[32:33]
    ds_read_b64 v[40:41], v162 offset:5120
    s_mov_b64 exec, -1
    ds_read_b128 v[32:35], v161 offset:5120
    v_exp_f32 v66, v66
    v_exp_f32 v67, v67
    v_exp_f32 v68, v68
    v_exp_f32 v69, v69
    v_mfma_f32_32x32x16_bf16 v[80:95], v[36:39], v[20:23], 0
    v_exp_f32 v70, v70
    v_exp_f32 v71, v71
    v_exp_f32 v72, v72
    v_exp_f32 v73, v73
    v_mfma_f32_32x32x8_bf16 v[80:95], v[42:43], v[30:31], v[80:95]
    v_exp_f32 v74, v74
    v_exp_f32 v75, v75
    v_exp_f32 v76, v76
    v_exp_f32 v77, v77
    v_smfmac_f32_32x32x32_bf16 v[128:143], v[56:59], v[64:71], v4
    v_exp_f32 v78, v78
    v_exp_f32 v79, v79
    v_exp_f32 v80, v80
    v_exp_f32 v81, v81
    v_smfmac_f32_32x32x32_bf16 v[128:143], v[60:63], v[72:79], v4
    v_exp_f32 v82, v82
    v_exp_f32 v83, v83
    v_exp_f32 v84, v84
    v_exp_f32 v85, v85
    s_waitcnt lgkmcnt(0)
    v_mfma_f32_32x32x16_bf16 v[64:79], v[32:35], v[8:11], 0
    s_mov_b64 exec, s[32:33]
    ds_read_b64 v[42:43], v162 offset:5128
    s_mov_b64 exec, -1
    ds_read_b128 v[36:39], v161 offset:6144
    s_mov_b64 exec, s[30:31]
    ds_read_b128 v[48:51], v163 offset:5120
    ds_read_b128 v[52:55], v163 offset:5760
    s_mov_b64 exec, -1
    v_exp_f32 v86, v86
    v_exp_f32 v87, v87
    v_exp_f32 v88, v88
    v_exp_f32 v89, v89
    v_mfma_f32_32x32x8_bf16 v[64:79], v[40:41], v[24:25], v[64:79]
    v_exp_f32 v90, v90
    v_exp_f32 v91, v91
    v_exp_f32 v92, v92
    v_exp_f32 v93, v93
    v_smfmac_f32_32x32x32_bf16 v[144:159], v[56:59], v[80:87], v4
    v_exp_f32 v94, v94
    v_exp_f32 v95, v95
    v_exp_f32 v64, v64
    v_exp_f32 v65, v65
    v_smfmac_f32_32x32x32_bf16 v[144:159], v[60:63], v[88:95], v4
    s_mov_b64 exec, s[30:31]
    ds_read_b128 v[56:59], v163 offset:6400
    ds_read_b128 v[60:63], v163 offset:7040
    s_mov_b64 exec, -1
    v_exp_f32 v66, v66
    v_exp_f32 v67, v67
    v_exp_f32 v68, v68
    v_exp_f32 v69, v69
    v_mfma_f32_32x32x16_bf16 v[80:95], v[32:35], v[12:15], 0
    v_exp_f32 v70, v70
    v_exp_f32 v71, v71
    v_exp_f32 v72, v72
    v_exp_f32 v73, v73
    v_mfma_f32_32x32x8_bf16 v[80:95], v[40:41], v[26:27], v[80:95]
    v_exp_f32 v74, v74
    v_exp_f32 v75, v75
    v_exp_f32 v76, v76
    v_exp_f32 v77, v77
    s_waitcnt lgkmcnt(2)
    v_smfmac_f32_32x32x32_bf16 v[96:111], v[48:51], v[64:71], v4
    v_exp_f32 v78, v78
    v_exp_f32 v79, v79
    v_exp_f32 v80, v80
    v_exp_f32 v81, v81
    v_smfmac_f32_32x32x32_bf16 v[96:111], v[52:55], v[72:79], v4
    s_waitcnt lgkmcnt(0)
    s_cbranch_vccz p2_skd1
    s_setprio 3
    s_add_u32 m0, s49, 5120
    s_nop 0
    buffer_load_dwordx4 v1, s[8:11], s36 offen offset:0 lds
    buffer_load_dwordx4 v1, s[8:11], s36 offen offset:1024 lds
    buffer_load_dwordx4 v1, s[8:11], s36 offen offset:2048 lds
    buffer_load_dwordx4 v1, s[8:11], s36 offen offset:3072 lds
    s_add_u32 m0, s49, 9216
    s_nop 0
    buffer_load_dwordx4 v160, s[8:11], s36 offen lds
    s_setprio 0
    s_add_u32 s36, s36, 5120
    s_cmp_lg_u32 s36, s54
    s_cselect_b32 s36, s36, s44
p2_skd1:
    v_exp_f32 v82, v82
    v_exp_f32 v83, v83
    v_exp_f32 v84, v84
    v_exp_f32 v85, v85
    v_mfma_f32_32x32x16_bf16 v[64:79], v[32:35], v[16:19], 0
    v_exp_f32 v86, v86
    v_exp_f32 v87, v87
    v_exp_f32 v88, v88
    v_exp_f32 v89, v89
    v_mfma_f32_32x32x8_bf16 v[64:79], v[40:41], v[28:29], v[64:79]
    v_exp_f32 v90, v90
    v_exp_f32 v91, v91
    v_exp_f32 v92, v92
    v_exp_f32 v93, v93
    v_smfmac_f32_32x32x32_bf16 v[112:127], v[48:51], v[80:87], v4
    v_exp_f32 v94, v94
    v_exp_f32 v95, v95
    v_exp_f32 v64, v64
    v_exp_f32 v65, v65
    v_smfmac_f32_32x32x32_bf16 v[112:127], v[52:55], v[88:95], v4
    v_exp_f32 v66, v66
    v_exp_f32 v67, v67
    v_exp_f32 v68, v68
    v_exp_f32 v69, v69
    v_mfma_f32_32x32x16_bf16 v[80:95], v[32:35], v[20:23], 0
    v_exp_f32 v70, v70
    v_exp_f32 v71, v71
    v_exp_f32 v72, v72
    v_exp_f32 v73, v73
    v_mfma_f32_32x32x8_bf16 v[80:95], v[40:41], v[30:31], v[80:95]
    v_exp_f32 v74, v74
    v_exp_f32 v75, v75
    v_exp_f32 v76, v76
    v_exp_f32 v77, v77
    v_smfmac_f32_32x32x32_bf16 v[128:143], v[48:51], v[64:71], v4
    v_exp_f32 v78, v78
    v_exp_f32 v79, v79
    v_exp_f32 v80, v80
    v_exp_f32 v81, v81
    v_smfmac_f32_32x32x32_bf16 v[128:143], v[52:55], v[72:79], v4
    v_exp_f32 v82, v82
    v_exp_f32 v83, v83
    v_exp_f32 v84, v84
    v_exp_f32 v85, v85
    v_mfma_f32_32x32x16_bf16 v[64:79], v[36:39], v[8:11], 0
    v_exp_f32 v86, v86
    v_exp_f32 v87, v87
    v_exp_f32 v88, v88
    v_exp_f32 v89, v89
    v_mfma_f32_32x32x8_bf16 v[64:79], v[42:43], v[24:25], v[64:79]
    v_exp_f32 v90, v90
    v_exp_f32 v91, v91
    v_exp_f32 v92, v92
    v_exp_f32 v93, v93
    v_smfmac_f32_32x32x32_bf16 v[144:159], v[48:51], v[80:87], v4
    v_exp_f32 v94, v94
    v_exp_f32 v95, v95
    v_exp_f32 v64, v64
    v_exp_f32 v65, v65
    v_smfmac_f32_32x32x32_bf16 v[144:159], v[52:55], v[88:95], v4
    v_exp_f32 v66, v66
    v_exp_f32 v67, v67
    v_exp_f32 v68, v68
    v_exp_f32 v69, v69
    v_mfma_f32_32x32x16_bf16 v[80:95], v[36:39], v[12:15], 0
    v_exp_f32 v70, v70
    v_exp_f32 v71, v71
    v_exp_f32 v72, v72
    v_exp_f32 v73, v73
    v_mfma_f32_32x32x8_bf16 v[80:95], v[42:43], v[26:27], v[80:95]
    v_exp_f32 v74, v74
    v_exp_f32 v75, v75
    v_exp_f32 v76, v76
    v_exp_f32 v77, v77
    v_smfmac_f32_32x32x32_bf16 v[96:111], v[56:59], v[64:71], v4
    v_exp_f32 v78, v78
    v_exp_f32 v79, v79
    v_exp_f32 v80, v80
    v_exp_f32 v81, v81
    v_smfmac_f32_32x32x32_bf16 v[96:111], v[60:63], v[72:79], v4
    v_exp_f32 v82, v82
    v_exp_f32 v83, v83
    v_exp_f32 v84, v84
    v_exp_f32 v85, v85
    v_mfma_f32_32x32x16_bf16 v[64:79], v[36:39], v[16:19], 0
    v_exp_f32 v86, v86
    v_exp_f32 v87, v87
    v_exp_f32 v88, v88
    v_exp_f32 v89, v89
    v_mfma_f32_32x32x8_bf16 v[64:79], v[42:43], v[28:29], v[64:79]
    v_exp_f32 v90, v90
    v_exp_f32 v91, v91
    v_exp_f32 v92, v92
    v_exp_f32 v93, v93
    v_smfmac_f32_32x32x32_bf16 v[112:127], v[56:59], v[80:87], v4
    v_exp_f32 v94, v94
    v_exp_f32 v95, v95
    v_exp_f32 v64, v64
    v_exp_f32 v65, v65
    v_smfmac_f32_32x32x32_bf16 v[112:127], v[60:63], v[88:95], v4
    s_waitcnt vmcnt(5)
    s_cbranch_vccz p2_w01
p2_w01_b:
    s_mov_b64 exec, s[32:33]
    ds_read_b64 v[40:41], v162 offset:0
    s_mov_b64 exec, -1
    ds_read_b128 v[32:35], v161 offset:0
    v_exp_f32 v66, v66
    v_exp_f32 v67, v67
    v_exp_f32 v68, v68
    v_exp_f32 v69, v69
    v_mfma_f32_32x32x16_bf16 v[80:95], v[36:39], v[20:23], 0
    v_exp_f32 v70, v70
    v_exp_f32 v71, v71
    v_exp_f32 v72, v72
    v_exp_f32 v73, v73
    v_mfma_f32_32x32x8_bf16 v[80:95], v[42:43], v[30:31], v[80:95]
    v_exp_f32 v74, v74
    v_exp_f32 v75, v75
    v_exp_f32 v76, v76
    v_exp_f32 v77, v77
    v_smfmac_f32_32x32x32_bf16 v[128:143], v[56:59], v[64:71], v4
    v_exp_f32 v78, v78
    v_exp_f32 v79, v79
    v_exp_f32 v80, v80
    v_exp_f32 v81, v81
    v_smfmac_f32_32x32x32_bf16 v[128:143], v[60:63], v[72:79], v4
    v_exp_f32 v82, v82
    v_exp_f32 v83, v83
    v_exp_f32 v84, v84
    v_exp_f32 v85, v85
    s_waitcnt lgkmcnt(0)
    v_mfma_f32_32x32x16_bf16 v[64:79], v[32:35], v[8:11], 0
    s_mov_b64 exec, s[32:33]
    ds_read_b64 v[42:43], v162 offset:8
    s_mov_b64 exec, -1
    ds_read_b128 v[36:39], v161 offset:1024
    s_mov_b64 exec, s[30:31]
    ds_read_b128 v[48:51], v163 offset:0
    ds_read_b128 v[52:55], v163 offset:640
    s_mov_b64 exec, -1
    v_exp_f32 v86, v86
    v_exp_f32 v87, v87
    v_exp_f32 v88, v88
    v_exp_f32 v89, v89
    v_mfma_f32_32x32x8_bf16 v[64:79], v[40:41], v[24:25], v[64:79]
    v_exp_f32 v90, v90
    v_exp_f32 v91, v91
    v_exp_f32 v92, v92
    v_exp_f32 v93, v93
    v_smfmac_f32_32x32x32_bf16 v[144:159], v[56:59], v[80:87], v4
    s_cmp_gt_u32 s38, 1
    s_cselect_b64 vcc, -1, 0
    s_sub_u32 s38, s38, 1
    v_exp_f32 v94, v94
    v_exp_f32 v95, v95
    s_cbranch_scc0 p2_aloop
    s_nop 1
    v_smfmac_f32_32x32x32_bf16 v[144:159], v[60:63], v[88:95], v4
    s_waitcnt lgkmcnt(0)
    ds_write_b128 v161, v[112:115] offset:0
    ds_write_b128 v161, v[116:119] offset:1024
    ds_write_b128 v161, v[120:123] offset:2048
    ds_write_b128 v161, v[128:131] offset:3072
    ds_write_b128 v161, v[132:135] offset:4096
    ds_write_b128 v161, v[136:139] offset:5120
    s_nop 4
    ds_write_b128 v161, v[144:147] offset:6144
    ds_write_b128 v161, v[148:151] offset:7168
    ds_write_b128 v161, v[152:155] offset:8192
    s_waitcnt lgkmcnt(0)
    v_mov_b32 v5, s46
    v_mov_b32 v6, 1
    s_mov_b64 exec, 1
    ds_add_u32 v5, v6 offset:0
    s_mov_b64 exec, -1
    s_add_u32 s29, s29, 4
p2_sy1_spin:
    ds_read_b32 v6, v5 offset:0
    s_waitcnt lgkmcnt(0)
    v_readfirstlane_b32 s25, v6
    s_cmp_ge_u32 s25, s29
    s_cbranch_scc1 p2_sy1_done
    s_sleep 3
    s_sub_u32 s68, s68, 1
    s_cbranch_scc0 p2_sy1_spin
    s_mov_b32 s68, 0
p2_sy1_done:
    s_setprio 2
    ds_read_b128 v[112:115], v164 offset:0
    ds_read_b128 v[116:119], v164 offset:1024
    ds_read_b128 v[120:123], v164 offset:2048
    ds_read_b128 v[124:127], v165 offset:0
    ds_read_b128 v[128:131], v165 offset:1024
    ds_read_b128 v[132:135], v165 offset:2048
    ds_read_b128 v[136:139], v166 offset:0
    ds_read_b128 v[140:143], v166 offset:1024
    ds_read_b128 v[144:147], v166 offset:2048
    s_waitcnt lgkmcnt(6)
    v_add_f32 v96, v96, v112
    v_add_f32 v97, v97, v113
    v_add_f32 v98, v98, v114
    v_add_f32 v99, v99, v115
    v_add_f32 v100, v100, v116
    v_add_f32 v101, v101, v117
    v_add_f32 v102, v102, v118
    v_add_f32 v103, v103, v119
    v_add_f32 v104, v104, v120
    v_add_f32 v105, v105, v121
    v_add_f32 v106, v106, v122
    v_add_f32 v107, v107, v123
    s_waitcnt lgkmcnt(3)
    v_add_f32 v96, v96, v124
    v_add_f32 v97, v97, v125
    v_add_f32 v98, v98, v126
    v_add_f32 v99, v99, v127
    v_add_f32 v100, v100, v128
    v_add_f32 v101, v101, v129
    v_add_f32 v102, v102, v130
    v_add_f32 v103, v103, v131
    v_add_f32 v104, v104, v132
    v_add_f32 v105, v105, v133
    v_add_f32 v106, v106, v134
    v_add_f32 v107, v107, v135
    s_waitcnt lgkmcnt(0)
    v_add_f32 v96, v96, v136
    v_add_f32 v97, v97, v137
    v_add_f32 v98, v98, v138
    v_add_f32 v99, v99, v139
    v_add_f32 v100, v100, v140
    v_add_f32 v101, v101, v141
    v_add_f32 v102, v102, v142
    v_add_f32 v103, v103, v143
    v_add_f32 v104, v104, v144
    v_add_f32 v105, v105, v145
    v_add_f32 v106, v106, v146
    v_add_f32 v107, v107, v147
    v_mov_b32 v112, v104
    v_mov_b32 v113, v104
    v_mul_f32 v114, 0, v96
    v_fma_f32 v114, v97, 0, v114
    v_permlane32_swap_b32 v112, v113
    v_fma_f32 v114, v98, 0, v114
    v_fma_f32 v114, v99, 0, v114
    v_rcp_f32 v112, v113
    v_mov_b32 v115, 0x7b800000
    v_mul_f32 v116, v96, v112
    v_mul_f32 v117, v97, v112
    v_mul_f32 v118, v98, v112
    v_mul_f32 v119, v99, v112
    v_mul_f32 v120, v100, v112
    v_mul_f32 v121, v101, v112
    v_mul_f32 v122, v102, v112
    v_mul_f32 v123, v103, v112
    v_mul_f32 v124, v104, v112
    v_mul_f32 v125, v105, v112
    v_mul_f32 v126, v106, v112
    v_mul_f32 v127, v107, v112
    v_cvt_pk_bf16_f32 v116, v116, v117
    v_cvt_pk_bf16_f32 v117, v118, v119
    v_cvt_pk_bf16_f32 v118, v120, v121
    v_cvt_pk_bf16_f32 v119, v122, v123
    v_cvt_pk_bf16_f32 v120, v124, v125
    v_cvt_pk_bf16_f32 v121, v126, v127
    buffer_store_dwordx4 v[116:119], v44, s[8:11], s55 offen sc1
    s_mov_b64 exec, s[32:33]
    buffer_store_dwordx2 v[120:121], v44, s[8:11], s67 offen sc1
    s_mov_b64 exec, -1
    v_fma_f32 v114, v100, 0, v114
    v_fma_f32 v114, v101, 0, v114
    v_fma_f32 v114, v102, 0, v114
    v_fma_f32 v114, v103, 0, v114
    v_fma_f32 v114, v104, 0, v114
    v_fma_f32 v114, v105, 0, v114
    v_fma_f32 v114, v106, 0, v114
    v_fma_f32 v114, v107, 0, v114
    v_add_f32 v114, v114, v113
    v_cmp_nle_f32 vcc, 0x1f800000, v114
    v_cmp_nle_f32 s[34:35], v114, v115
    s_nop 3
    s_or_b64 vcc, vcc, s[34:35]
    v_mov_b32 v5, 151552
    v_mov_b32 v6, 1
    s_cmp_lg_u32 s43, 0
    s_cbranch_scc1 p2_pub
    s_cbranch_vccz p2_pub
    ds_write_b32 v5, v6 offset:8
p2_pub:
    s_lshr_b32 s28, s24, 2
    s_lshl_b32 s28, s28, 8
    s_add_u32 s28, s28, 0x1204800
    v_mov_b32 v5, 151552
    v_mov_b32 v6, 1
    s_mov_b64 exec, 1
    s_waitcnt vmcnt(0)
    ds_add_rtn_u32 v7, v5, v6 offset:56
    ds_read_b32 v3, v5 offset:8
    s_waitcnt lgkmcnt(0)
    v_readfirstlane_b32 s25, v7
    v_readfirstlane_b32 s26, v3
    s_and_b32 s25, s25, 7
    s_cmp_lg_u32 s25, 7
    s_cbranch_scc1 p2_notlast
    s_andn2_b32 s26, s26, s43
    s_cbranch_scc1 p2_lastbad
    buffer_atomic_add v6, off, s[8:11], s28
    ds_write_b32 v5, v6 offset:24
    s_branch k_fin
p2_lastbad:
    v_mov_b32 v6, 2
    ds_write_b32 v5, v6 offset:24
p2_notlast:
    s_mov_b64 exec, -1
    s_cmp_lg_u32 s43, 0
    s_cbranch_scc1 k_fin
    s_setprio 0
p2_dec_spin:
    ds_read_b32 v6, v5 offset:24
    s_waitcnt lgkmcnt(0)
    v_readfirstlane_b32 s25, v6
    s_cmp_ge_u32 s25, 1
    s_cbranch_scc1 p2_dec_done
    s_sleep 8
    s_sub_u32 s68, s68, 1
    s_cbranch_scc0 p2_dec_spin
    s_mov_b32 s68, 0
p2_dec_done:
    s_cmp_eq_u32 s25, 1
    s_cbranch_scc1 k_fin
p2_fb:
    s_setprio 0
    v_mov_b32 v112, 0xff800000
    v_mov_b32 v113, 0xff800000
    v_mov_b32 v114, 0xff800000
    v_mov_b32 v115, 0xff800000
    s_mov_b32 s36, s44
    s_mov_b32 s38, 8
p2_mx:
    s_mov_b64 exec, s[32:33]
    buffer_load_dwordx2 v[40:41], v2, s[8:11], s36 offen offset:0 sc1
    s_mov_b64 exec, -1
    buffer_load_dwordx4 v[32:35], v1, s[8:11], s36 offen offset:0 sc1
    s_mov_b64 exec, s[32:33]
    buffer_load_dwordx2 v[42:43], v2, s[8:11], s36 offen offset:8 sc1
    s_mov_b64 exec, -1
    buffer_load_dwordx4 v[36:39], v1, s[8:11], s36 offen offset:1024 sc1
    s_waitcnt vmcnt(0)
    v_mfma_f32_32x32x16_bf16 v[64:79], v[32:35], v[8:11], 0
    v_mfma_f32_32x32x8_bf16 v[64:79], v[40:41], v[24:25], v[64:79]
    s_nop 7
    s_nop 3
    v_max3_f32 v112, v64, v65, v112
    v_max3_f32 v112, v66, v67, v112
    v_max3_f32 v112, v68, v69, v112
    v_max3_f32 v112, v70, v71, v112
    v_max3_f32 v112, v72, v73, v112
    v_max3_f32 v112, v74, v75, v112
    v_max3_f32 v112, v76, v77, v112
    v_max3_f32 v112, v78, v79, v112
    v_mfma_f32_32x32x16_bf16 v[64:79], v[32:35], v[12:15], 0
    v_mfma_f32_32x32x8_bf16 v[64:79], v[40:41], v[26:27], v[64:79]
    s_nop 7
    s_nop 3
    v_max3_f32 v113, v64, v65, v113
    v_max3_f32 v113, v66, v67, v113
    v_max3_f32 v113, v68, v69, v113
    v_max3_f32 v113, v70, v71, v113
    v_max3_f32 v113, v72, v73, v113
    v_max3_f32 v113, v74, v75, v113
    v_max3_f32 v113, v76, v77, v113
    v_max3_f32 v113, v78, v79, v113
    v_mfma_f32_32x32x16_bf16 v[64:79], v[32:35], v[16:19], 0
    v_mfma_f32_32x32x8_bf16 v[64:79], v[40:41], v[28:29], v[64:79]
    s_nop 7
    s_nop 3
    v_max3_f32 v114, v64, v65, v114
    v_max3_f32 v114, v66, v67, v114
    v_max3_f32 v114, v68, v69, v114
    v_max3_f32 v114, v70, v71, v114
    v_max3_f32 v114, v72, v73, v114
    v_max3_f32 v114, v74, v75, v114
    v_max3_f32 v114, v76, v77, v114
    v_max3_f32 v114, v78, v79, v114
    v_mfma_f32_32x32x16_bf16 v[64:79], v[32:35], v[20:23], 0
    v_mfma_f32_32x32x8_bf16 v[64:79], v[40:41], v[30:31], v[64:79]
    s_nop 7
    s_nop 3
    v_max3_f32 v115, v64, v65, v115
    v_max3_f32 v115, v66, v67, v115
    v_max3_f32 v115, v68, v69, v115
    v_max3_f32 v115, v70, v71, v115
    v_max3_f32 v115, v72, v73, v115
    v_max3_f32 v115, v74, v75, v115
    v_max3_f32 v115, v76, v77, v115
    v_max3_f32 v115, v78, v79, v115
    v_mfma_f32_32x32x16_bf16 v[64:79], v[36:39], v[8:11], 0
    v_mfma_f32_32x32x8_bf16 v[64:79], v[42:43], v[24:25], v[64:79]
    s_nop 7
    s_nop 3
    v_max3_f32 v112, v64, v65, v112
    v_max3_f32 v112, v66, v67, v112
    v_max3_f32 v112, v68, v69, v112
    v_max3_f32 v112, v70, v71, v112
    v_max3_f32 v112, v72, v73, v112
    v_max3_f32 v112, v74, v75, v112
    v_max3_f32 v112, v76, v77, v112
    v_max3_f32 v112, v78, v79, v112
    v_mfma_f32_32x32x16_bf16 v[64:79], v[36:39], v[12:15], 0
    v_mfma_f32_32x32x8_bf16 v[64:79], v[42:43], v[26:27], v[64:79]
    s_nop 7
    s_nop 3
    v_max3_f32 v113, v64, v65, v113
    v_max3_f32 v113, v66, v67, v113
    v_max3_f32 v113, v68, v69, v113
    v_max3_f32 v113, v70, v71, v113
    v_max3_f32 v113, v72, v73, v113
    v_max3_f32 v113, v74, v75, v113
    v_max3_f32 v113, v76, v77, v113
    v_max3_f32 v113, v78, v79, v113
    v_mfma_f32_32x32x16_bf16 v[64:79], v[36:39], v[16:19], 0
    v_mfma_f32_32x32x8_bf16 v[64:79], v[42:43], v[28:29], v[64:79]
    s_nop 7
    s_nop 3
    v_max3_f32 v114, v64, v65, v114
    v_max3_f32 v114, v66, v67, v114
    v_max3_f32 v114, v68, v69, v114
    v_max3_f32 v114, v70, v71, v114
    v_max3_f32 v114, v72, v73, v114
    v_max3_f32 v114, v74, v75, v114
    v_max3_f32 v114, v76, v77, v114
    v_max3_f32 v114, v78, v79, v114
    v_mfma_f32_32x32x16_bf16 v[64:79], v[36:39], v[20:23], 0
    v_mfma_f32_32x32x8_bf16 v[64:79], v[42:43], v[30:31], v[64:79]
    s_nop 7
    s_nop 3
    v_max3_f32 v115, v64, v65, v115
    v_max3_f32 v115, v66, v67, v115
    v_max3_f32 v115, v68, v69, v115
    v_max3_f32 v115, v70, v71, v115
    v_max3_f32 v115, v72, v73, v115
    v_max3_f32 v115, v74, v75, v115
    v_max3_f32 v115, v76, v77, v115
    v_max3_f32 v115, v78, v79, v115
    s_add_u32 s36, s36, 5120
    s_sub_u32 s38, s38, 1
    s_cmp_lg_u32 s38, 0
    s_cbranch_scc1 p2_mx
    v_lshlrev_b32 v7, 2, v0
    v_and_b32 v7, 127, v7
    v_mov_b32 v5, v112
    s_nop 1
    v_permlane32_swap_b32 v112, v5
    s_nop 1
    v_max_f32 v112, v112, v5
    s_add_u32 s25, s41, 0
    s_and_b32 s25, s25, 3
    s_lshl_b32 s25, s25, 9
    s_lshl_b32 s26, s42, 11
    s_add_u32 s25, s25, s26
    s_add_u32 s25, s25, 147456
    v_add_u32 v116, s25, v7
    s_lshl_b32 s26, s41, 7
    v_add_u32 v5, s26, v116
    ds_write_b32 v5, v112
    v_mov_b32 v5, v113
    s_nop 1
    v_permlane32_swap_b32 v113, v5
    s_nop 1
    v_max_f32 v113, v113, v5
    s_add_u32 s25, s41, 1
    s_and_b32 s25, s25, 3
    s_lshl_b32 s25, s25, 9
    s_lshl_b32 s26, s42, 11
    s_add_u32 s25, s25, s26
    s_add_u32 s25, s25, 147456
    v_add_u32 v117, s25, v7
    s_lshl_b32 s26, s41, 7
    v_add_u32 v5, s26, v117
    ds_write_b32 v5, v113
    v_mov_b32 v5, v114
    s_nop 1
    v_permlane32_swap_b32 v114, v5
    s_nop 1
    v_max_f32 v114, v114, v5
    s_add_u32 s25, s41, 2
    s_and_b32 s25, s25, 3
    s_lshl_b32 s25, s25, 9
    s_lshl_b32 s26, s42, 11
    s_add_u32 s25, s25, s26
    s_add_u32 s25, s25, 147456
    v_add_u32 v118, s25, v7
    s_lshl_b32 s26, s41, 7
    v_add_u32 v5, s26, v118
    ds_write_b32 v5, v114
    v_mov_b32 v5, v115
    s_nop 1
    v_permlane32_swap_b32 v115, v5
    s_nop 1
    v_max_f32 v115, v115, v5
    s_add_u32 s25, s41, 3
    s_and_b32 s25, s25, 3
    s_lshl_b32 s25, s25, 9
    s_lshl_b32 s26, s42, 11
    s_add_u32 s25, s25, s26
    s_add_u32 s25, s25, 147456
    v_add_u32 v119, s25, v7
    s_lshl_b32 s26, s41, 7
    v_add_u32 v5, s26, v119
    ds_write_b32 v5, v115
    s_waitcnt lgkmcnt(0)
    v_mov_b32 v5, s46
    v_mov_b32 v6, 1
    s_mov_b64 exec, 1
    ds_add_u32 v5, v6 offset:0
    s_mov_b64 exec, -1
    s_add_u32 s29, s29, 4
p2_sy3_spin:
    ds_read_b32 v6, v5 offset:0
    s_waitcnt lgkmcnt(0)
    v_readfirstlane_b32 s25, v6
    s_cmp_ge_u32 s25, s29
    s_cbranch_scc1 p2_sy3_done
    s_sleep 1
    s_sub_u32 s68, s68, 1
    s_cbranch_scc0 p2_sy3_spin
    s_mov_b32 s68, 0
p2_sy3_done:
    s_mov_b32 s26, 0xffff0000
    ds_read_b32 v120, v116 offset:0
    ds_read_b32 v121, v116 offset:128
    ds_read_b32 v122, v116 offset:256
    ds_read_b32 v123, v116 offset:384
    s_waitcnt lgkmcnt(0)
    v_max3_f32 v5, v120, v121, v122
    v_max_f32 v5, v5, v123
    v_sub_f32 v5, 0, v5
    v_and_b32 v6, s26, v5
    v_sub_f32 v5, v5, v6
    v_and_b32 v7, s26, v5
    v_sub_f32 v5, v5, v7
    v_lshrrev_b32 v6, 16, v6
    v_or_b32 v6, v6, v7
    v_lshrrev_b32 v5, 16, v5
    s_not_b64 exec, s[32:33]
    v_mov_b32 v24, v6
    v_mov_b32 v25, v5
    s_mov_b64 exec, -1
    ds_read_b32 v120, v117 offset:0
    ds_read_b32 v121, v117 offset:128
    ds_read_b32 v122, v117 offset:256
    ds_read_b32 v123, v117 offset:384
    s_waitcnt lgkmcnt(0)
    v_max3_f32 v5, v120, v121, v122
    v_max_f32 v5, v5, v123
    v_sub_f32 v5, 0, v5
    v_and_b32 v6, s26, v5
    v_sub_f32 v5, v5, v6
    v_and_b32 v7, s26, v5
    v_sub_f32 v5, v5, v7
    v_lshrrev_b32 v6, 16, v6
    v_or_b32 v6, v6, v7
    v_lshrrev_b32 v5, 16, v5
    s_not_b64 exec, s[32:33]
    v_mov_b32 v26, v6
    v_mov_b32 v27, v5
    s_mov_b64 exec, -1
    ds_read_b32 v120, v118 offset:0
    ds_read_b32 v121, v118 offset:128
    ds_read_b32 v122, v118 offset:256
    ds_read_b32 v123, v118 offset:384
    s_waitcnt lgkmcnt(0)
    v_max3_f32 v5, v120, v121, v122
    v_max_f32 v5, v5, v123
    v_sub_f32 v5, 0, v5
    v_and_b32 v6, s26, v5
    v_sub_f32 v5, v5, v6
    v_and_b32 v7, s26, v5
    v_sub_f32 v5, v5, v7
    v_lshrrev_b32 v6, 16, v6
    v_or_b32 v6, v6, v7
    v_lshrrev_b32 v5, 16, v5
    s_not_b64 exec, s[32:33]
    v_mov_b32 v28, v6
    v_mov_b32 v29, v5
    s_mov_b64 exec, -1
    ds_read_b32 v120, v119 offset:0
    ds_read_b32 v121, v119 offset:128
    ds_read_b32 v122, v119 offset:256
    ds_read_b32 v123, v119 offset:384
    s_waitcnt lgkmcnt(0)
    v_max3_f32 v5, v120, v121, v122
    v_max_f32 v5, v5, v123
    v_sub_f32 v5, 0, v5
    v_and_b32 v6, s26, v5
    v_sub_f32 v5, v5, v6
    v_and_b32 v7, s26, v5
    v_sub_f32 v5, v5, v7
    v_lshrrev_b32 v6, 16, v6
    v_or_b32 v6, v6, v7
    v_lshrrev_b32 v5, 16, v5
    s_not_b64 exec, s[32:33]
    v_mov_b32 v30, v6
    v_mov_b32 v31, v5
    s_mov_b64 exec, -1
    s_mov_b32 s43, 1
    s_mov_b32 s36, s44
    s_setprio 3
    s_add_u32 m0, s49, 0
    s_nop 0
    buffer_load_dwordx4 v1, s[8:11], s36 offen offset:0 lds
    buffer_load_dwordx4 v1, s[8:11], s36 offen offset:1024 lds
    buffer_load_dwordx4 v1, s[8:11], s36 offen offset:2048 lds
    buffer_load_dwordx4 v1, s[8:11], s36 offen offset:3072 lds
    s_add_u32 m0, s49, 4096
    s_nop 0
    buffer_load_dwordx4 v160, s[8:11], s36 offen lds
    s_setprio 0
    s_add_u32 s36, s36, 5120
    s_cmp_lg_u32 s36, s54
    s_cselect_b32 s36, s36, s44
    s_setprio 3
    s_add_u32 m0, s49, 5120
    s_nop 0
    buffer_load_dwordx4 v1, s[8:11], s36 offen offset:0 lds
    buffer_load_dwordx4 v1, s[8:11], s36 offen offset:1024 lds
    buffer_load_dwordx4 v1, s[8:11], s36 offen offset:2048 lds
    buffer_load_dwordx4 v1, s[8:11], s36 offen offset:3072 lds
    s_add_u32 m0, s49, 9216
    s_nop 0
    buffer_load_dwordx4 v160, s[8:11], s36 offen lds
    s_setprio 0
    s_add_u32 s36, s36, 5120
    s_cmp_lg_u32 s36, s54
    s_cselect_b32 s36, s36, s44
    s_waitcnt vmcnt(5)
    s_branch p2_pass
p2_w00:
    s_waitcnt vmcnt(0)
    s_branch p2_w00_b
p2_w01:
    s_waitcnt vmcnt(0)
    s_branch p2_w01_b
k_last:
    s_endpgm
.section .rodata,"a"
.p2align 6
.amdhsa_kernel parallel_sum__mha_block__mixer_token_mlp__prompt_kernel
  .amdhsa_next_free_vgpr 168
  .amdhsa_next_free_sgpr 100
  .amdhsa_accum_offset 168
  .amdhsa_group_segment_fixed_size 0
  .amdhsa_kernarg_size 88
  .amdhsa_user_sgpr_count 2
  .amdhsa_user_sgpr_kernarg_segment_ptr 1
  .amdhsa_system_sgpr_workgroup_id_x 1
.end_amdhsa_kernel
```
